```python
import torch

def _softmax(x, axis=-1):
    return torch.softmax(x, dim=axis)
def _gelu(x):
    return torch.nn.functional.gelu(x, approximate="tanh")
def _silu(x):
    return torch.nn.functional.silu(x)
def _sigmoid(x):
    return torch.sigmoid(x)
def _layernorm(x, axis=-1, eps=1e-5):
    m = x.mean(dim=axis, keepdim=True)
    v = x.var(dim=axis, keepdim=True, unbiased=False)
    return (x - m) / torch.sqrt(v + eps)
def _scatter_add(tgt, idx, src, axis=0):
    return tgt.clone().index_add_(axis, idx, src)
def _segment_sum(src, seg, n):
    out = torch.zeros((n,) + src.shape[1:], dtype=src.dtype)
    return out.index_add_(0, seg, src)
def _pad(x, pw):
    flat = tuple(v for pair in reversed(pw) for v in pair)
    return torch.nn.functional.pad(x, flat)

kernel_name = 'sequential_preLN__linear_attn_block__glu_gated_geglu__prompt'

def setup_inputs():

    _w = (lambda a: (lambda t: t.to(torch.bfloat16) if t.is_floating_point() else t)(torch.as_tensor(a)))
    def _A_setup():
        B, S, D = 1, 2048, 448
        return {
            "x": _w((lambda *s: torch.randn(*s, dtype=torch.bfloat16) * 0.05)(B, S, D)),
            "wqkv": _w((lambda *s: torch.randn(*s, dtype=torch.bfloat16) * 0.1)(D, 3 * D)),
            "wo": _w((lambda *s: torch.randn(*s, dtype=torch.bfloat16) * 0.05)(D, D)),
        }
    _A_in = _A_setup()

    def _B_setup():
        B, S, Dm, Df = 1, 2048, 448, 1792
        return {
            "x": _w((lambda *s: torch.randn(*s, dtype=torch.bfloat16) * 0.05)(B, S, Dm)),
            "w_gate": _w((lambda *s: torch.randn(*s, dtype=torch.bfloat16) * 0.4)(Dm, Df) * (Dm ** -0.5)),
            "w_up": _w((lambda *s: torch.randn(*s, dtype=torch.bfloat16) * 0.4)(Dm, Df) * (Dm ** -0.5)),
            "w_down": _w((lambda *s: torch.randn(*s, dtype=torch.bfloat16) * 0.4)(Df, Dm) * (Df ** -0.5)),
        }
    _B_in = _B_setup()

    return {
        "A_x": _A_in["x"],
        "A_wqkv": _A_in["wqkv"],
        "A_wo": _A_in["wo"],
        "B_x": _B_in["x"],
        "B_w_gate": _B_in["w_gate"],
        "B_w_up": _B_in["w_up"],
        "B_w_down": _B_in["w_down"],
    }

def reference(A_x, A_wqkv, A_wo, B_x, B_w_gate, B_w_up, B_w_down):
    def _A_ref(x, wqkv, wo):
        B, S, D = x.shape
        H = 16; Dh = D // H
        qkv = (lambda x, *d: x.permute(*d))((x @ wqkv).reshape(B, S, 3, H, Dh), 2, 0, 3, 1, 4)
        q, k, v = qkv[0], qkv[1], qkv[2]
        phi = lambda t: torch.where(t > 0, t + 1, torch.exp(t)) + 1e-6
        pq, pk = phi(q), phi(k)
        kv = torch.einsum("bhsd,bhse->bhde", pk, v)
        z = torch.einsum("bhsd->bhd", pk)
        num = torch.einsum("bhqd,bhde->bhqe", pq, kv)
        den = torch.einsum("bhqd,bhd->bhq", pq, z)[..., None] + 1e-6
        o = num / den
        return (lambda x, *d: x.permute(*d))(o, 0, 2, 1, 3).reshape(B, S, D) @ wo

    def _B_ref(x, w_gate, w_up, w_down):
        g = torch.einsum("bsd,df->bsf", x, w_gate)
        u = torch.einsum("bsd,df->bsf", x, w_up)
        h = _gelu(g) * u
        return torch.einsum("bsf,fd->bsd", h, w_down)

    x = A_x
    h = x + _A_ref(_layernorm(x, axis=-1), A_wqkv, A_wo)
    h2 = h + _B_ref(_layernorm(h, axis=-1), B_w_gate, B_w_up, B_w_down)
    return h2
```

```asm
; @launch grid=(256,1,1) block=(256,1,1) lds=163840
.amdgcn_target "amdgcn-amd-amdhsa--gfx950"
.text
.p2align 12
.fill 832, 4, 0xbf810000
.globl sequential_preLN__linear_attn_block__glu_gated_geglu__prompt_kernel
.p2align 8
.type sequential_preLN__linear_attn_block__glu_gated_geglu__prompt_kernel,@function
sequential_preLN__linear_attn_block__glu_gated_geglu__prompt_kernel:
    s_getpc_b64 s[4:5]
    s_lshr_b32 s6, s2, 3
    s_lshl_b32 s7, s6, 10
    v_lshl_add_u32 v20, v0, 2, s7
    s_cmp_ge_u32 s6, 32
    s_cbranch_scc1 L_exit
    global_load_dword v255, v20, s[4:5]
    s_load_dwordx2 s[8:9], s[0:1], 0
    s_load_dwordx2 s[12:13], s[0:1], 8
    s_load_dwordx2 s[36:37], s[0:1], 72
    s_load_dwordx2 s[16:17], s[0:1], 16
    s_load_dwordx2 s[20:21], s[0:1], 32
    s_load_dwordx2 s[24:25], s[0:1], 40
    s_load_dwordx2 s[28:29], s[0:1], 48
    s_load_dwordx2 s[32:33], s[0:1], 56
    v_lshrrev_b32 v22, 6, v0
    v_and_b32 v1, 63, v0
    v_readfirstlane_b32 s3, v22
    s_and_b32 s45, s2, 1
    s_bfe_u32 s44, s2, 0x20001
    s_lshr_b32 s7, s2, 6
    s_lshl2_add_u32 s44, s44, s7
    s_and_b32 s6, s6, 7
    s_lshl3_add_u32 s46, s45, s6
    s_lshl1_add_u32 s51, s7, s6
    s_sub_u32 s7, s51, 7
    s_cselect_b32 s51, s51, s7
    s_mov_b32 s10, 1835008
    s_mov_b32 s11, 0x20000
    s_mov_b32 s14, 1204224
    s_mov_b32 s15, 0x20000
    s_lshl4_add_u32 s89, s44, s46
    s_lshl2_add_u32 s89, s89, s3
    s_mul_i32 s4, s89, 1792
    v_and_b32 v152, 31, v1
    v_lshrrev_b32 v153, 5, v1
    v_cmp_lt_u32 vcc, 27, v152
    v_mul_u32_u24 v21, 896, v153
    v_lshl_add_u32 v21, v152, 4, v21
    v_cndmask_b32 v20, v21, 2.0, vcc
    s_mul_i32 s5, s3, 43008
    s_mul_i32 s7, s46, 56
    s_add_u32 s7, s7, s5
    v_lshrrev_b32 v22, 2, v1
    v_mul_u32_u24 v22, 2688, v22
    v_and_b32 v23, 3, v1
    v_lshlrev_b32 v23, 4, v23
    v_min_u32 v23, 40, v23
    v_add3_u32 v6, v22, v23, s7
    s_lshl_b32 s50, s3, 10
    s_lshl_b32 s53, s3, 12
    s_lshl2_add_u32 s52, s44, s3
    s_mul_i32 s52, s52, 28672
    v_lshrrev_b32 v22, 3, v1
    v_mul_u32_u24 v22, 896, v22
    v_add_u32 v22, s52, v22
    v_lshrrev_b32 v23, 4, v1
    v_and_b32 v21, 7, v1
    v_xor_b32 v23, v23, v21
    v_lshl_add_u32 v2, v23, 4, v22
    v_xor_b32 v23, 4, v23
    v_lshl_add_u32 v3, v23, 4, v22
    v_add_u32 v3, 6144, v3
    v_add_u32 v4, 12288, v2
    v_add_u32 v5, 12288, v3
    s_lshl_b32 s72, s51, 7
    s_mul_i32 s65, s72, 1344
    s_waitcnt lgkmcnt(0)
    buffer_load_dwordx4 v[192:195], v20, s[8:11], s4 offen
    buffer_load_dwordx4 v[196:199], v20, s[8:11], s4 offen offset:448
    s_mov_b32 s4, 688128
    s_load_dword s40, s[36:37], s4
    s_add_u32 m0, s50, 114688
    s_add_u32 s88, s65, 896
    buffer_load_dwordx4 v6, s[12:15], s88 offen lds
    s_add_u32 m0, s53, 65536
    s_nop 0
    buffer_load_dwordx4 v2, s[8:11], s72 offen lds
    buffer_load_dwordx4 v3, s[8:11], s72 offen offset:1024 lds
    buffer_load_dwordx4 v4, s[8:11], s72 offen offset:2048 lds
    buffer_load_dwordx4 v5, s[8:11], s72 offen offset:3072 lds
    s_add_u32 s73, s72, 128
    s_cmp_eq_u32 s73, 896
    s_cselect_b32 s73, 0, s73
    s_mul_i32 s66, s73, 1344
    s_add_u32 s74, s73, 128
    s_cmp_eq_u32 s74, 896
    s_cselect_b32 s74, 0, s74
    s_mul_i32 s67, s74, 1344
    s_add_u32 s75, s74, 128
    s_cmp_eq_u32 s75, 896
    s_cselect_b32 s75, 0, s75
    s_mul_i32 s68, s75, 1344
    s_add_u32 s76, s75, 128
    s_cmp_eq_u32 s76, 896
    s_cselect_b32 s76, 0, s76
    s_mul_i32 s69, s76, 1344
    s_add_u32 s77, s76, 128
    s_cmp_eq_u32 s77, 896
    s_cselect_b32 s77, 0, s77
    s_mul_i32 s70, s77, 1344
    s_add_u32 s78, s77, 128
    s_cmp_eq_u32 s78, 896
    s_cselect_b32 s78, 0, s78
    s_mul_i32 s71, s78, 1344
    s_add_u32 m0, s50, 118784
    s_add_u32 s88, s66, 896
    buffer_load_dwordx4 v6, s[12:15], s88 offen lds
    v_lshlrev_b32 v15, 4, v1
    v_bfe_u32 v154, v1, 2, 2
    v_bfe_u32 v155, v1, 4, 1
    v_and_b32 v156, 3, v1
    v_bfe_u32 v20, v1, 1, 3
    v_xor_b32 v20, v20, v153
    v_lshlrev_b32 v20, 4, v20
    v_lshl_add_u32 v20, v152, 7, v20
    s_add_u32 s4, s53, 0x10000
    v_add_u32 v20, s4, v20
    v_lshl_add_u32 v21, v153, 3, v154
    v_lshlrev_b32 v21, 6, v21
    v_lshl_add_u32 v22, v155, 2, v156
    v_cmp_lt_u32 vcc, 5, v22
    v_xor_b32 v23, 1, v22
    s_mov_b32 s54, 0x3f803f80
    v_cndmask_b32 v22, v22, v23, vcc
    v_lshl_add_u32 v21, v22, 3, v21
    v_add_u32 v22, 32768, v21
    v_add_u32 v21, 114688, v21
    s_add_u32 s4, s3, 0
    s_and_b32 s4, s4, 3
    s_lshl_b32 s5, s4, 5
    s_add_u32 m0, s53, 81920
    s_nop 0
    buffer_load_dwordx4 v2, s[8:11], s73 offen lds
    v_xor_b32 v7, s5, v20
    v_lshl_add_u32 v11, s4, 10, v21
    v_lshl_add_u32 v144, s4, 12, v22
    s_add_u32 s4, s3, 1
    s_and_b32 s4, s4, 3
    s_lshl_b32 s5, s4, 5
    v_xor_b32 v8, s5, v20
    v_lshl_add_u32 v12, s4, 10, v21
    v_lshl_add_u32 v145, s4, 12, v22
    s_add_u32 s4, s3, 2
    s_and_b32 s4, s4, 3
    buffer_load_dwordx4 v3, s[8:11], s73 offen offset:1024 lds
    s_lshl_b32 s5, s4, 5
    v_xor_b32 v9, s5, v20
    v_lshl_add_u32 v13, s4, 10, v21
    v_lshl_add_u32 v146, s4, 12, v22
    s_add_u32 s4, s3, 3
    s_and_b32 s4, s4, 3
    s_lshl_b32 s5, s4, 5
    v_xor_b32 v10, s5, v20
    v_lshl_add_u32 v14, s4, 10, v21
    v_lshl_add_u32 v147, s4, 12, v22
    s_mov_b32 vcc_lo, 0xf0f00f0f
    buffer_load_dwordx4 v4, s[8:11], s73 offen offset:2048 lds
    s_mov_b32 vcc_hi, 0xf0f00f0f
    v_mov_b32 v20, s54
    v_cndmask_b32 v20, 0, v20, vcc
    v_accvgpr_write_b32 a224, v20
    v_accvgpr_write_b32 a248, -1
    v_accvgpr_write_b32 a225, v20
    v_accvgpr_write_b32 a249, -1
    v_accvgpr_write_b32 a226, v20
    v_accvgpr_write_b32 a250, -1
    v_accvgpr_write_b32 a227, v20
    v_accvgpr_write_b32 a251, -1
    buffer_load_dwordx4 v5, s[8:11], s73 offen offset:3072 lds
    s_mov_b32 s38, 16777216
    s_mov_b32 s39, 0x20000
    v_lshlrev_b32 v174, 3, v1
    s_lshl2_add_u32 s43, s46, s3
    s_lshl_b32 s43, s43, 13
    s_lshl_b32 s4, s44, 9
    s_add_u32 s60, s43, s4
    s_lshl_b32 s89, s89, 7
    s_add_u32 s89, s89, 786432
    v_lshlrev_b32 v150, 4, v156
    v_lshl_add_u32 v150, v153, 6, v150
    v_mov_b32 v200, 0
    v_mov_b32 v202, 0
    s_waitcnt vmcnt(10)
    s_add_u32 m0, s50, 122880
    s_add_u32 s88, s67, 896
    buffer_load_dwordx4 v6, s[12:15], s88 offen lds
    v_dot2c_f32_bf16 v200, s54, v192
    v_dot2c_f32_bf16 v202, v192, v192
    v_dot2c_f32_bf16 v200, s54, v193
    v_dot2c_f32_bf16 v202, v193, v193
    v_dot2c_f32_bf16 v200, s54, v194
    v_dot2c_f32_bf16 v202, v194, v194
    v_dot2c_f32_bf16 v200, s54, v195
    v_dot2c_f32_bf16 v202, v195, v195
    v_dot2c_f32_bf16 v200, s54, v196
    v_dot2c_f32_bf16 v202, v196, v196
    v_dot2c_f32_bf16 v200, s54, v197
    v_dot2c_f32_bf16 v202, v197, v197
    v_dot2c_f32_bf16 v200, s54, v198
    v_dot2c_f32_bf16 v202, v198, v198
    v_dot2c_f32_bf16 v200, s54, v199
    v_dot2c_f32_bf16 v202, v199, v199
    s_nop 1
    v_add_f32_dpp v200, v200, v200 quad_perm:[1,0,3,2] row_mask:0xf bank_mask:0xf
    v_add_f32_dpp v202, v202, v202 quad_perm:[1,0,3,2] row_mask:0xf bank_mask:0xf
    s_add_u32 m0, s53, 98304
    s_nop 0
    buffer_load_dwordx4 v2, s[8:11], s74 offen lds
    v_add_f32_dpp v200, v200, v200 quad_perm:[2,3,0,1] row_mask:0xf bank_mask:0xf
    v_add_f32_dpp v202, v202, v202 quad_perm:[2,3,0,1] row_mask:0xf bank_mask:0xf
    s_nop 0
    v_add_f32_dpp v200, v200, v200 row_half_mirror row_mask:0xf bank_mask:0xf
    v_add_f32_dpp v202, v202, v202 row_half_mirror row_mask:0xf bank_mask:0xf
    s_nop 0
    v_add_f32_dpp v200, v200, v200 row_mirror row_mask:0xf bank_mask:0xf
    v_add_f32_dpp v202, v202, v202 row_mirror row_mask:0xf bank_mask:0xf
    v_mov_b32 v201, v200
    v_mov_b32 v203, v202
    buffer_load_dwordx4 v3, s[8:11], s74 offen offset:1024 lds
    v_permlane16_swap_b32 v200, v201
    v_permlane16_swap_b32 v202, v203
    v_add_f32 v200, v200, v201
    v_add_f32 v202, v202, v203
    v_mul_f32 v200, 0x3b124925, v200
    v_mul_f32 v202, 0x3b124925, v202
    v_fma_f32 v202, -v200, v200, v202
    v_max_f32 v202, 0, v202
    buffer_load_dwordx4 v4, s[8:11], s74 offen offset:2048 lds
    v_add_f32 v202, 0x3727c5ac, v202
    v_rsq_f32 v202, v202
    s_waitcnt lgkmcnt(0)
    s_mul_i32 s40, s40, 0x9e3779b1
    s_add_u32 s40, s40, 0x7f4a7c15
    v_xor_b32 v201, s40, v200
    v_xor_b32 v203, s40, v202
    s_mov_b32 exec_lo, 15
    s_mov_b32 exec_hi, 15
    buffer_store_dwordx4 v[200:203], v150, s[36:39], s89 offen sc1
    s_mov_b64 exec, -1
    buffer_store_dwordx2 a[248:249], v174, s[36:39], s60 offen sc1
    buffer_load_dwordx4 v5, s[8:11], s74 offen offset:3072 lds
    s_lshl4_add_u32 s4, s46, s44
    s_lshl_b32 s4, s4, 7
    s_add_u32 s94, s4, 524288
    s_lshl2_add_u32 s4, s46, s3
    s_lshl_b32 s4, s4, 9
    s_add_u32 s41, s4, 524288
    v_lshlrev_b32 v175, 7, v156
    s_lshl2_add_u32 s4, s44, s3
    s_add_u32 m0, s50, 126976
    s_add_u32 s88, s68, 896
    buffer_load_dwordx4 v6, s[12:15], s88 offen lds
    s_lshl_b32 s4, s4, 11
    s_add_u32 s93, s4, 786432
    v_lshlrev_b32 v150, 6, v152
    v_lshlrev_b32 v172, 4, v152
    v_add_u32 v172, 160768, v172
    v_lshl_add_u32 v167, s3, 2, v172
    s_lshl_b32 s6, s3, 8
    s_add_u32 s6, s6, 159744
    v_lshl_add_u32 v30, v153, 4, s6
    v_lshl_add_u32 v173, v1, 2, s6
    s_mov_b32 s0, 0
    s_mov_b32 s1, -1
    s_and_b32 s6, s46, 7
    s_sub_u32 s7, 4, s45
    s_cmp_eq_u32 s6, s7
    s_cselect_b32 s49, 0x100, 0
    s_add_u32 m0, s53, 0
    s_nop 0
    buffer_load_dwordx4 v2, s[8:11], s75 offen lds
    s_cmp_gt_u32 s6, s7
    s_cselect_b32 s7, 1, 0
    s_sub_u32 s47, s6, s7
    s_min_u32 s47, s47, 6
    s_mul_i32 s48, s45, 7
    s_add_u32 s48, s48, s47
    s_mov_b32 s7, s44
    s_or_b32 s49, s49, s7
    s_and_b32 s87, s3, 1
    buffer_load_dwordx4 v3, s[8:11], s75 offen offset:1024 lds
    s_mov_b32 s22, 1605632
    s_mov_b32 s23, 0x20000
    s_mov_b32 s26, 1606656
    s_mov_b32 s27, 0x20000
    s_sub_u32 s24, s24, 1024
    s_subb_u32 s25, s25, 0
    s_lshl2_add_u32 s4, s48, s3
    s_lshl_b32 s5, s4, 6
    v_lshrrev_b32 v20, 2, v1
    buffer_load_dwordx4 v4, s[8:11], s75 offen offset:2048 lds
    v_mul_u32_u24 v20, 3584, v20
    v_and_b32 v21, 0x30, v15
    v_add3_u32 v24, v20, v21, s5
    v_xor_b32 v25, 32, v24
    s_mul_i32 s91, s7, 224
    s_add_u32 s91, s91, s4
    s_lshl_b32 s91, s91, 11
    s_add_u32 s91, s91, 6291456
    buffer_load_dwordx4 v5, s[8:11], s75 offen offset:3072 lds
    s_and_b32 s4, s7, 3
    s_mul_i32 s4, s4, 7
    s_lshr_b32 s5, s7, 2
    s_lshl_b32 s5, s5, 2
    s_lshr_b32 s5, 0x5230, s5
    s_and_b32 s5, s5, 15
    s_add_u32 s51, s4, s5
    s_mul_i32 s95, s51, 57344
    s_waitcnt vmcnt(17)
    s_barrier
    ds_read_b128 v[32:35], v7
    ds_read_b64_tr_b16 a[160:161], v11
    ds_read_b64_tr_b16 a[162:163], v11 offset:256
    ds_read_b128 v[36:39], v8
    ds_read_b64_tr_b16 a[164:165], v12
    ds_read_b64_tr_b16 a[166:167], v12 offset:256
    ds_read_b128 v[40:43], v9
    ds_read_b64_tr_b16 a[168:169], v13
    ds_read_b64_tr_b16 a[170:171], v13 offset:256
    ds_read_b128 v[44:47], v10
    ds_read_b64_tr_b16 a[172:173], v14
    ds_read_b64_tr_b16 a[174:175], v14 offset:256
    s_add_u32 m0, s50, 131072
    s_add_u32 s88, s69, 896
    buffer_load_dwordx4 v6, s[12:15], s88 offen lds
    s_waitcnt vmcnt(13)
    s_barrier
    s_waitcnt lgkmcnt(9)
    v_mfma_f32_16x16x32_bf16 a[240:243], a[224:227], a[160:163], 0
    v_mfma_f32_32x32x16_bf16 v[176:191], v[32:35], a[160:163], 0
    ds_read_b128 v[48:51], v7 offset:16384
    ds_read_b64_tr_b16 a[176:177], v11 offset:4096
    ds_read_b64_tr_b16 a[178:179], v11 offset:4352
    s_lshl_b32 s4, s44, 2
    s_add_u32 s61, s4, s3
    s_lshl4_add_u32 s61, s61, s46
    s_lshl_b32 s61, s61, 11
    s_add_u32 s61, s61, 1048576
    v_lshrrev_b32 v20, 3, v1
    s_and_b32 s5, s3, 2
    s_add_u32 s5, s5, s45
    s_add_u32 s5, s5, s4
    s_waitcnt lgkmcnt(9)
    v_mfma_f32_32x32x16_bf16 v[176:191], v[36:39], a[164:167], v[176:191]
    s_add_u32 m0, s53, 16384
    s_nop 0
    buffer_load_dwordx4 v2, s[8:11], s76 offen lds
    ds_read_b128 v[52:55], v8 offset:16384
    ds_read_b64_tr_b16 a[180:181], v12 offset:4096
    ds_read_b64_tr_b16 a[182:183], v12 offset:4352
    s_lshl1_add_u32 s7, s47, s87
    s_mul_i32 s63, s5, 14
    s_add_u32 s63, s63, s7
    v_mul_u32_u24 v20, 896, v20
    s_lshl_b32 s62, s63, 11
    s_add_u32 s62, s62, 3145728
    buffer_load_dwordx4 v3, s[8:11], s76 offen offset:1024 lds
    s_lshl_b32 s63, s63, 8
    s_add_u32 s63, s63, 5242880
    s_lshl1_add_u32 s5, s5, s87
    s_waitcnt lgkmcnt(9)
    v_mfma_f32_32x32x16_bf16 v[176:191], v[40:43], a[168:171], v[176:191]
    ds_read_b128 v[56:59], v9 offset:16384
    ds_read_b64_tr_b16 a[184:185], v13 offset:4096
    ds_read_b64_tr_b16 a[186:187], v13 offset:4352
    buffer_load_dwordx4 v4, s[8:11], s76 offen offset:2048 lds
    s_mul_i32 s52, s5, 14336
    v_and_b32 v21, 0x70, v15
    s_lshl_b32 s5, s5, 3
    s_sub_u32 s5, s5, s87
    s_lshl_b32 s5, s5, 11
    s_add_u32 s79, s5, 1048576
    s_add_u32 s80, s5, 1050624
    s_add_u32 s81, s5, 1054720
    s_add_u32 s82, s5, 1058816
    s_waitcnt lgkmcnt(9)
    v_mfma_f32_32x32x16_bf16 v[176:191], v[44:47], a[172:175], v[176:191]
    buffer_load_dwordx4 v5, s[8:11], s76 offen offset:3072 lds
    ds_read_b128 v[60:63], v10 offset:16384
    ds_read_b64_tr_b16 a[188:189], v14 offset:4096
    ds_read_b64_tr_b16 a[190:191], v14 offset:4352
    s_add_u32 s83, s5, 1062912
    s_add_u32 s84, s5, 1052672
    s_add_u32 s85, s5, 1056768
    s_add_u32 s86, s5, 1060864
    s_lshl_b32 s6, s87, 14
    s_add_u32 s79, s79, s6
    v_lshlrev_b32 v22, 6, v155
    s_mov_b32 s56, 0x3fb8aa3b
    s_mov_b32 s57, 0x3fb8aa3b
    s_add_u32 m0, s50, 135168
    s_add_u32 s88, s70, 896
    buffer_load_dwordx4 v6, s[12:15], s88 offen lds
    s_waitcnt vmcnt(11)
    s_barrier
    s_waitcnt lgkmcnt(9)
    v_mfma_f32_16x16x32_bf16 a[240:243], a[224:227], a[176:179], a[240:243]
    v_mfma_f32_32x32x16_bf16 v[176:191], v[48:51], a[176:179], v[176:191]
    ds_read_b128 v[64:67], v7 offset:32768
    ds_read_b64_tr_b16 a[160:161], v11 offset:8192
    ds_read_b64_tr_b16 a[162:163], v11 offset:8448
    s_mov_b32 s58, 0x358637bd
    s_mov_b32 s59, 0x358637bd
    v_xor_b32 v21, v21, v22
    s_lshl_b32 s4, s47, 7
    v_add3_u32 v16, v20, v21, s4
    v_add_u32 v17, 6144, v16
    s_mov_b32 s18, 401408
    s_mov_b32 s19, 0x20000
    s_mov_b32 s30, 1605632
    s_waitcnt lgkmcnt(9)
    v_mfma_f32_32x32x16_bf16 v[176:191], v[52:55], a[180:183], v[176:191]
    s_add_u32 m0, s53, 32768
    s_nop 0
    buffer_load_dwordx4 v2, s[8:11], s77 offen lds
    ds_read_b128 v[68:71], v8 offset:32768
    ds_read_b64_tr_b16 a[164:165], v12 offset:8192
    ds_read_b64_tr_b16 a[166:167], v12 offset:8448
    s_mov_b32 s31, 0x20000
    s_mov_b32 s34, 1835008
    s_mov_b32 s35, 0x20000
    v_lshl_add_u32 v20, v153, 2, v154
    v_lshlrev_b32 v20, 6, v20
    v_mul_u32_u24 v21, 1056, v155
    v_lshlrev_b32 v22, 3, v156
    buffer_load_dwordx4 v3, s[8:11], s77 offen offset:1024 lds
    v_add3_u32 v20, v20, v21, v22
    v_add_u32 v26, s53, v20
    s_waitcnt lgkmcnt(9)
    v_mfma_f32_32x32x16_bf16 v[176:191], v[56:59], a[184:187], v[176:191]
    ds_read_b128 v[72:75], v9 offset:32768
    ds_read_b64_tr_b16 a[168:169], v13 offset:8192
    ds_read_b64_tr_b16 a[170:171], v13 offset:8448
    v_xor_b32 v27, 32, v26
    buffer_load_dwordx4 v4, s[8:11], s77 offen offset:2048 lds
    s_mul_i32 s97, s3, 7168
    s_mul_i32 s92, s3, 100352
    s_mul_i32 s96, s3, 14336
    s_add_u32 s96, s96, 65536
    v_bfe_u32 v28, v1, 1, 3
    s_lshl_b32 s4, s87, 2
    v_xor_b32 v28, s4, v28
    v_lshlrev_b32 v28, 4, v28
    s_waitcnt lgkmcnt(9)
    v_mfma_f32_32x32x16_bf16 v[176:191], v[60:63], a[188:191], v[176:191]
    buffer_load_dwordx4 v5, s[8:11], s77 offen offset:3072 lds
    ds_read_b128 v[76:79], v10 offset:32768
    ds_read_b64_tr_b16 a[172:173], v14 offset:8192
    ds_read_b64_tr_b16 a[174:175], v14 offset:8448
    v_lshl_add_u32 v28, v152, 7, v28
    v_lshl_add_u32 v28, v153, 3, v28
    s_lshr_b32 s4, s3, 1
    s_lshl_b32 s4, s4, 12
    s_add_u32 s4, s4, 151552
    v_add_u32 v28, s4, v28
    v_add_u32 v148, 98304, v15
    v_add_u32 v148, s53, v148
    v_lshrrev_b32 v20, 4, v1
    s_add_u32 m0, s50, 139264
    s_add_u32 s88, s71, 896
    buffer_load_dwordx4 v6, s[12:15], s88 offen lds
    s_waitcnt vmcnt(11)
    s_barrier
    v_subrev_u32 v7, 0x10000, v7
    s_waitcnt lgkmcnt(9)
    v_mfma_f32_16x16x32_bf16 a[240:243], a[224:227], a[160:163], a[240:243]
    v_mfma_f32_32x32x16_bf16 v[176:191], v[64:67], a[160:163], v[176:191]
    ds_read_b128 v[80:83], v7
    ds_read_b64_tr_b16 a[176:177], v11 offset:12288
    ds_read_b64_tr_b16 a[178:179], v11 offset:12544
    v_and_b32 v21, 0xf0, v15
    v_lshl_add_u32 v20, v20, 9, v21
    s_lshr_b32 s4, s3, 1
    s_lshl_b32 s5, s4, 8
    s_add_u32 s5, s5, 98304
    v_add_u32 v149, s5, v20
    s_lshl_b32 s5, s87, 8
    s_add_u32 s5, s5, 100352
    v_add_u32 v159, s5, v20
    s_add_u32 m0, s53, 49152
    s_nop 0
    buffer_load_dwordx4 v2, s[8:11], s78 offen lds
    v_subrev_u32 v8, 0x10000, v8
    s_waitcnt lgkmcnt(9)
    v_mfma_f32_32x32x16_bf16 v[176:191], v[68:71], a[164:167], v[176:191]
    ds_read_b128 v[84:87], v8
    ds_read_b64_tr_b16 a[180:181], v12 offset:12288
    ds_read_b64_tr_b16 a[182:183], v12 offset:12544
    v_add_u32 v158, 122880, v15
    buffer_load_dwordx4 v3, s[8:11], s78 offen offset:1024 lds
    v_and_b32 v21, 7, v1
    v_lshl_add_u32 v21, v21, 1, v153
    v_lshl_add_u32 v21, s87, 4, v21
    v_max_u32 v20, 24, v21
    v_lshlrev_b32 v20, 2, v20
    s_mov_b32 s5, 0x30415533
    v_bfe_u32 v20, s5, v20, 4
    v_add_u32 v20, v20, v21
    v_subrev_u32 v9, 0x10000, v9
    s_waitcnt lgkmcnt(9)
    v_mfma_f32_32x32x16_bf16 v[176:191], v[72:75], a[168:171], v[176:191]
    buffer_load_dwordx4 v4, s[8:11], s78 offen offset:2048 lds
    ds_read_b128 v[88:91], v9
    ds_read_b64_tr_b16 a[184:185], v13 offset:12288
    ds_read_b64_tr_b16 a[186:187], v13 offset:12544
    v_bfe_u32 v21, v1, 3, 1
    v_lshl_add_u32 v20, v21, 5, v20
    v_lshlrev_b32 v20, 4, v20
    v_lshl_add_u32 v20, v155, 3, v20
    s_lshl_b32 s4, s4, 10
    buffer_load_dwordx4 v5, s[8:11], s78 offen offset:3072 lds
    s_add_u32 s4, s4, 122832
    v_add_u32 v157, s4, v20
    s_bitcmp1_b32 s49, 8
    s_cselect_b32 s62, 16777216, s62
    s_cselect_b32 s63, 16777216, s63
    s_cmp_lt_u32 s3, 2
    s_cselect_b32 s90, s62, 16777216
    v_subrev_u32 v10, 0x10000, v10
    s_waitcnt lgkmcnt(9)
    v_mfma_f32_32x32x16_bf16 v[176:191], v[76:79], a[172:175], v[176:191]
    buffer_load_dwordx4 v[192:195], v150, s[36:39], s93 offen sc1
    ds_read_b128 v[92:95], v10
    ds_read_b64_tr_b16 a[188:189], v14 offset:12288
    ds_read_b64_tr_b16 a[190:191], v14 offset:12544
    s_waitcnt vmcnt(11)
    s_barrier
    s_waitcnt lgkmcnt(9)
    v_mfma_f32_16x16x32_bf16 a[240:243], a[224:227], a[176:179], a[240:243]
    v_mfma_f32_32x32x16_bf16 v[176:191], v[80:83], a[176:179], v[176:191]
    ds_read_b128 v[96:99], v7 offset:16384
    ds_read_b64_tr_b16 a[160:161], v11 offset:16384
    ds_read_b64_tr_b16 a[162:163], v11 offset:16640
    s_waitcnt lgkmcnt(9)
    v_mfma_f32_32x32x16_bf16 v[176:191], v[84:87], a[180:183], v[176:191]
    ds_read_b128 v[100:103], v8 offset:16384
    ds_read_b64_tr_b16 a[164:165], v12 offset:16384
    ds_read_b64_tr_b16 a[166:167], v12 offset:16640
    s_waitcnt lgkmcnt(9)
    v_mfma_f32_32x32x16_bf16 v[176:191], v[88:91], a[184:187], v[176:191]
    ds_read_b128 v[104:107], v9 offset:16384
    ds_read_b64_tr_b16 a[168:169], v13 offset:16384
    ds_read_b64_tr_b16 a[170:171], v13 offset:16640
    s_waitcnt lgkmcnt(9)
    v_mfma_f32_32x32x16_bf16 v[176:191], v[92:95], a[188:191], v[176:191]
    ds_read_b128 v[108:111], v10 offset:16384
    ds_read_b64_tr_b16 a[172:173], v14 offset:16384
    ds_read_b64_tr_b16 a[174:175], v14 offset:16640
    s_add_u32 m0, s53, 65536
    s_add_u32 s88, s65, 1792
    buffer_load_dwordx4 v6, s[12:15], s88 offen lds
    s_waitcnt vmcnt(7)
    s_barrier
    s_cmp_lg_u32 s3, 3
    s_cbranch_scc1 L_cnt_3
    v_mov_b32 v164, s40
    v_mov_b32 v165, s40
    s_mov_b64 exec, 0xffff
    buffer_store_dwordx2 v[164:165], v174, s[36:39], s94 offen sc1
    s_mov_b64 exec, -1
L_cnt_3:
    s_waitcnt lgkmcnt(9)
    v_mfma_f32_16x16x32_bf16 a[240:243], a[224:227], a[160:163], a[240:243]
    v_mfma_f32_32x32x16_bf16 v[176:191], v[96:99], a[160:163], v[176:191]
    ds_read_b128 v[112:115], v7 offset:32768
    ds_read_b64_tr_b16 a[176:177], v11 offset:20480
    ds_read_b64_tr_b16 a[178:179], v11 offset:20736
    s_mov_b32 s98, 0x3f80
    s_mov_b32 s99, 0x3f800000
    s_lshl2_add_u32 s4, s44, s3
    s_mul_i32 s4, s4, 28672
    s_lshl_b32 s5, s47, 7
    s_waitcnt lgkmcnt(9)
    v_mfma_f32_32x32x16_bf16 v[176:191], v[100:103], a[164:167], v[176:191]
    ds_read_b128 v[116:119], v8 offset:32768
    ds_read_b64_tr_b16 a[180:181], v12 offset:20480
    ds_read_b64_tr_b16 a[182:183], v12 offset:20736
    s_add_u32 s52, s52, s5
    v_subrev_u32 v160, s4, v2
    s_add_u32 m0, s53, 66560
    s_add_u32 s88, s66, 1792
    buffer_load_dwordx4 v6, s[12:15], s88 offen lds
    v_subrev_u32 v161, s4, v3
    v_lshrrev_b32 v4, 1, v154
    v_xor_b32 v4, s87, v4
    s_waitcnt lgkmcnt(9)
    v_mfma_f32_32x32x16_bf16 v[176:191], v[104:107], a[168:171], v[176:191]
    ds_read_b128 v[120:123], v9 offset:32768
    ds_read_b64_tr_b16 a[184:185], v13 offset:20480
    ds_read_b64_tr_b16 a[186:187], v13 offset:20736
    v_lshlrev_b32 v4, 6, v4
    v_lshl_add_u32 v4, v154, 7, v4
    v_lshl_add_u32 v4, v155, 5, v4
    v_lshl_add_u32 v4, v156, 3, v4
    s_mul_i32 s4, s87, 53760
    s_waitcnt lgkmcnt(9)
    v_mfma_f32_32x32x16_bf16 v[176:191], v[108:111], a[172:175], v[176:191]
    ds_read_b128 v[124:127], v10 offset:32768
    ds_read_b64_tr_b16 a[188:189], v14 offset:20480
    ds_read_b64_tr_b16 a[190:191], v14 offset:20736
    s_add_u32 s4, s4, 65536
    v_add_u32 v4, s4, v4
    v_lshl_add_u32 v2, v153, 9, v4
    v_mul_u32_u24 v3, 320, v153
    v_xor_b32 v4, v3, v4
    s_add_u32 m0, s53, 67584
    s_add_u32 s88, s67, 1792
    buffer_load_dwordx4 v6, s[12:15], s88 offen lds
    s_waitcnt vmcnt(4)
    s_barrier
    s_waitcnt lgkmcnt(9)
    v_mfma_f32_16x16x32_bf16 a[240:243], a[224:227], a[176:179], a[240:243]
    v_mfma_f32_32x32x16_bf16 v[176:191], v[112:115], a[176:179], v[176:191]
    ds_read_b128 v[128:131], v7 offset:49152
    ds_read_b64_tr_b16 a[160:161], v11 offset:24576
    ds_read_b64_tr_b16 a[162:163], v11 offset:24832
    v_xor_b32 v5, 64, v4
    v_xor_b32 v3, 64, v2
    s_and_b32 s4, s2, 7
    s_min_u32 s4, s4, 6
    s_lshl_b32 s72, s4, 7
    s_waitcnt lgkmcnt(9)
    v_mfma_f32_32x32x16_bf16 v[176:191], v[116:119], a[180:183], v[176:191]
    ds_read_b128 v[132:135], v8 offset:49152
    ds_read_b64_tr_b16 a[164:165], v12 offset:24576
    ds_read_b64_tr_b16 a[166:167], v12 offset:24832
    s_add_u32 s73, s72, 128
    s_cmp_eq_u32 s73, 896
    s_cselect_b32 s73, 0, s73
    s_add_u32 s74, s73, 128
    s_add_u32 m0, s53, 68608
    s_add_u32 s88, s68, 1792
    buffer_load_dwordx4 v6, s[12:15], s88 offen lds
    s_cmp_eq_u32 s74, 896
    s_cselect_b32 s74, 0, s74
    s_add_u32 s75, s74, 128
    s_waitcnt lgkmcnt(9)
    v_mfma_f32_32x32x16_bf16 v[176:191], v[120:123], a[184:187], v[176:191]
    ds_read_b128 v[136:139], v9 offset:49152
    ds_read_b64_tr_b16 a[168:169], v13 offset:24576
    ds_read_b64_tr_b16 a[170:171], v13 offset:24832
    s_cmp_eq_u32 s75, 896
    s_cselect_b32 s75, 0, s75
    s_add_u32 s76, s75, 128
    s_cmp_eq_u32 s76, 896
    s_cselect_b32 s76, 0, s76
    s_add_u32 s77, s76, 128
    s_cmp_eq_u32 s77, 896
    s_cselect_b32 s77, 0, s77
    s_waitcnt lgkmcnt(9)
    v_mfma_f32_32x32x16_bf16 v[176:191], v[124:127], a[188:191], v[176:191]
    ds_read_b128 v[140:143], v10 offset:49152
    ds_read_b64_tr_b16 a[172:173], v14 offset:24576
    ds_read_b64_tr_b16 a[174:175], v14 offset:24832
    s_add_u32 s78, s77, 128
    s_cmp_eq_u32 s78, 896
    s_cselect_b32 s78, 0, s78
    s_waitcnt lgkmcnt(9)
    v_mfma_f32_16x16x32_bf16 a[240:243], a[224:227], a[160:163], a[240:243]
    v_mfma_f32_32x32x16_bf16 v[176:191], v[128:131], a[160:163], v[176:191]
    s_add_u32 m0, s53, 81920
    s_add_u32 s88, s69, 1792
    buffer_load_dwordx4 v6, s[12:15], s88 offen lds
    s_waitcnt vmcnt(5)
    v_bitop3_b32 v193, s40, v192, v193 bitop3:0x96
    s_waitcnt lgkmcnt(6)
    v_mfma_f32_32x32x16_bf16 v[176:191], v[132:135], a[164:167], v[176:191]
    v_bitop3_b32 v195, s40, v194, v195 bitop3:0x96
    v_or_b32 v193, v193, v195
    v_cmp_ne_u32 vcc, 0, v193
    s_cbranch_vccnz L_sv_1
L_svb_2:
    s_waitcnt lgkmcnt(3)
    v_mfma_f32_32x32x16_bf16 v[176:191], v[136:139], a[168:171], v[176:191]
    ds_write_b32 v167, a240
    v_mov_b32 v18, v192
    v_mov_b32 v19, v194
    v_cndmask_b32 v192, v192, v194, s[0:1]
    ds_write_b32 v173, v192
    ds_read_b128 v[224:227], v30
    ds_read_b128 v[228:231], v30 offset:32
    ds_read_b128 v[232:235], v30 offset:64
    ds_read_b128 v[236:239], v30 offset:96
    ds_read_b128 v[240:243], v30 offset:128
    ds_read_b128 v[244:247], v30 offset:160
    ds_read_b128 v[248:251], v30 offset:192
    ds_read_b128 v[252:255], v30 offset:224
    s_waitcnt lgkmcnt(10)
    v_mfma_f32_32x32x16_bf16 v[176:191], v[140:143], a[172:175], v[176:191]
    s_waitcnt lgkmcnt(9)
    s_waitcnt vmcnt(3)
    s_barrier
    ds_read_b128 v[168:171], v172
    ds_read_b64_tr_b16 a[176:177], v144 offset:32768
    ds_read_b64_tr_b16 a[178:179], v144 offset:33024
    ds_read_b64_tr_b16 a[180:181], v145 offset:32768
    ds_read_b64_tr_b16 a[182:183], v145 offset:33024
    ds_read_b64_tr_b16 a[184:185], v146 offset:32768
    ds_read_b64_tr_b16 a[186:187], v146 offset:33024
    ds_read_b64_tr_b16 a[188:189], v147 offset:32768
    ds_read_b64_tr_b16 a[190:191], v147 offset:33024
    ds_read_b64_tr_b16 a[160:161], v144 offset:33792
    ds_read_b64_tr_b16 a[162:163], v144 offset:34048
    ds_read_b64_tr_b16 a[164:165], v145 offset:33792
    ds_read_b64_tr_b16 a[166:167], v145 offset:34048
    s_add_u32 m0, s53, 82944
    s_add_u32 s88, s70, 1792
    buffer_load_dwordx4 v6, s[12:15], s88 offen lds
    s_mov_b32 vcc_lo, 0x30000000
    s_mov_b32 vcc_hi, 0x30000000
    v_mov_b32 v21, s54
    s_waitcnt lgkmcnt(8)
    v_mfma_f32_16x16x32_bf16 a[244:247], a[224:227], a[176:179], 0
    v_mfma_f32_32x32x16_bf16 v[192:207], v[32:35], a[176:179], 0
    ds_read_b64_tr_b16 a[168:169], v146 offset:33792
    ds_read_b64_tr_b16 a[170:171], v146 offset:34048
    v_add_f32 v168, v168, v169
    v_add_f32 v170, v170, v171
    v_add_f32 v164, v168, v170
    v_xor_b32 v164, 0x80000000, v164
    v_mfma_f32_32x32x16_bf16 v[192:207], v[36:39], a[180:183], v[192:207]
    ds_read_b64_tr_b16 a[172:173], v147 offset:33792
    ds_read_b64_tr_b16 a[174:175], v147 offset:34048
    v_mov_b32 v20, 0xb5c1a2a0
    s_waitcnt vmcnt(1)
    s_barrier
    s_waitcnt lgkmcnt(8)
    v_mfma_f32_32x32x16_bf16 v[192:207], v[40:43], a[184:187], v[192:207]
    ds_read_b64_tr_b16 a[176:177], v144 offset:34816
    ds_read_b64_tr_b16 a[178:179], v144 offset:35072
    v_fmac_f32 v176, v224, v164
    v_fmac_f32 v177, v225, v164
    v_fmac_f32 v178, v226, v164
    v_fmac_f32 v179, v227, v164
    v_fma_f32 v176, v176, v240, s58
    v_fma_f32 v177, v177, v241, s58
    v_mfma_f32_32x32x16_bf16 v[192:207], v[44:47], a[188:191], v[192:207]
    ds_read_b64_tr_b16 a[180:181], v145 offset:34816
    ds_read_b64_tr_b16 a[182:183], v145 offset:35072
    v_fma_f32 v178, v178, v242, s58
    v_fma_f32 v179, v179, v243, s58
    v_fma_f32 v216, v176, s56, v20
    v_fma_f32 v217, v177, s56, v20
    v_fma_f32 v218, v178, s56, v20
    s_waitcnt lgkmcnt(8)
    v_mfma_f32_16x16x32_bf16 a[244:247], a[224:227], a[160:163], a[244:247]
    v_mfma_f32_32x32x16_bf16 v[192:207], v[48:51], a[160:163], v[192:207]
    ds_read_b64_tr_b16 a[184:185], v146 offset:34816
    ds_read_b64_tr_b16 a[186:187], v146 offset:35072
    v_fma_f32 v219, v179, s56, v20
    v_exp_f32 v216, v216 clamp
    v_max_f32 v176, s58, v176
    v_exp_f32 v217, v217 clamp
    v_mfma_f32_32x32x16_bf16 v[192:207], v[52:55], a[164:167], v[192:207]
    ds_read_b64_tr_b16 a[188:189], v147 offset:34816
    ds_read_b64_tr_b16 a[190:191], v147 offset:35072
    v_max_f32 v177, s58, v177
    v_exp_f32 v218, v218 clamp
    v_max_f32 v178, s58, v178
    v_exp_f32 v219, v219 clamp
    s_waitcnt lgkmcnt(8)
    v_mfma_f32_32x32x16_bf16 v[192:207], v[56:59], a[168:171], v[192:207]
    ds_read_b64_tr_b16 a[160:161], v144 offset:35840
    ds_read_b64_tr_b16 a[162:163], v144 offset:36096
    v_max_f32 v179, s58, v179
    v_add_f32 v176, v176, v216
    v_add_f32 v177, v177, v217
    v_add_f32 v178, v178, v218
    v_add_f32 v179, v179, v219
    v_mfma_f32_32x32x16_bf16 v[192:207], v[60:63], a[172:175], v[192:207]
    ds_read_b64_tr_b16 a[164:165], v145 offset:35840
    ds_read_b64_tr_b16 a[166:167], v145 offset:36096
    s_add_u32 m0, s53, 83968
    s_add_u32 s88, s71, 1792
    buffer_load_dwordx4 v6, s[12:15], s88 offen lds
    v_cvt_pk_bf16_f32 v208, v176, v177
    v_cvt_pk_bf16_f32 v209, v178, v179
    v_fmac_f32 v180, v228, v164
    v_fmac_f32 v181, v229, v164
    v_fmac_f32 v182, v230, v164
    v_fmac_f32 v183, v231, v164
    s_waitcnt lgkmcnt(8)
    v_mfma_f32_16x16x32_bf16 a[244:247], a[224:227], a[176:179], a[244:247]
    v_mfma_f32_32x32x16_bf16 v[192:207], v[64:67], a[176:179], v[192:207]
    ds_read_b64_tr_b16 a[168:169], v146 offset:35840
    ds_read_b64_tr_b16 a[170:171], v146 offset:36096
    v_fma_f32 v180, v180, v244, s58
    v_fma_f32 v181, v181, v245, s58
    v_fma_f32 v182, v182, v246, s58
    v_fma_f32 v183, v183, v247, s58
    v_fma_f32 v220, v180, s56, v20
    v_mfma_f32_32x32x16_bf16 v[192:207], v[68:71], a[180:183], v[192:207]
    ds_read_b64_tr_b16 a[172:173], v147 offset:35840
    ds_read_b64_tr_b16 a[174:175], v147 offset:36096
    v_fma_f32 v221, v181, s56, v20
    v_fma_f32 v222, v182, s56, v20
    v_fma_f32 v223, v183, s56, v20
    v_exp_f32 v220, v220 clamp
    s_waitcnt lgkmcnt(8)
    v_mfma_f32_32x32x16_bf16 v[192:207], v[72:75], a[184:187], v[192:207]
    ds_read_b64_tr_b16 a[176:177], v144 offset:49152
    ds_read_b64_tr_b16 a[178:179], v144 offset:49408
    v_max_f32 v180, s58, v180
    v_exp_f32 v221, v221 clamp
    v_max_f32 v181, s58, v181
    v_exp_f32 v222, v222 clamp
    v_mfma_f32_32x32x16_bf16 v[192:207], v[76:79], a[188:191], v[192:207]
    ds_read_b64_tr_b16 a[180:181], v145 offset:49152
    ds_read_b64_tr_b16 a[182:183], v145 offset:49408
    v_max_f32 v182, s58, v182
    v_exp_f32 v223, v223 clamp
    v_max_f32 v183, s58, v183
    v_add_f32 v180, v180, v220
    v_add_f32 v181, v181, v221
    s_waitcnt lgkmcnt(8)
    v_mfma_f32_16x16x32_bf16 a[244:247], a[224:227], a[160:163], a[244:247]
    v_mfma_f32_32x32x16_bf16 v[192:207], v[80:83], a[160:163], v[192:207]
    ds_read_b64_tr_b16 a[184:185], v146 offset:49152
    ds_read_b64_tr_b16 a[186:187], v146 offset:49408
    s_add_u32 m0, s53, 32768
    s_add_u32 s88, s65, 0
    buffer_load_dwordx4 v6, s[12:15], s88 offen lds
    v_add_f32 v182, v182, v222
    v_add_f32 v183, v183, v223
    v_cvt_pk_bf16_f32 v210, v180, v181
    v_cvt_pk_bf16_f32 v211, v182, v183
    v_fmac_f32 v184, v232, v164
    v_mfma_f32_32x32x16_bf16 v[192:207], v[84:87], a[164:167], v[192:207]
    ds_read_b64_tr_b16 a[188:189], v147 offset:49152
    ds_read_b64_tr_b16 a[190:191], v147 offset:49408
    v_fmac_f32 v185, v233, v164
    v_fmac_f32 v186, v234, v164
    v_fmac_f32 v187, v235, v164
    v_fma_f32 v184, v184, v248, s58
    v_fma_f32 v185, v185, v249, s58
    v_fma_f32 v186, v186, v250, s58
    s_waitcnt vmcnt(1)
    s_barrier
    s_waitcnt lgkmcnt(8)
    v_mfma_f32_32x32x16_bf16 v[192:207], v[88:91], a[168:171], v[192:207]
    ds_read_b64_tr_b16 a[160:161], v144 offset:50176
    ds_read_b64_tr_b16 a[162:163], v144 offset:50432
    v_fma_f32 v187, v187, v251, s58
    v_fma_f32 v216, v184, s56, v20
    v_fma_f32 v217, v185, s56, v20
    v_fma_f32 v218, v186, s56, v20
    v_fma_f32 v219, v187, s56, v20
    v_mfma_f32_32x32x16_bf16 v[192:207], v[92:95], a[172:175], v[192:207]
    ds_read_b64_tr_b16 a[164:165], v145 offset:50176
    ds_read_b64_tr_b16 a[166:167], v145 offset:50432
    v_exp_f32 v216, v216 clamp
    v_max_f32 v184, s58, v184
    v_exp_f32 v217, v217 clamp
    s_waitcnt lgkmcnt(8)
    v_mfma_f32_16x16x32_bf16 a[244:247], a[224:227], a[176:179], a[244:247]
    v_mfma_f32_32x32x16_bf16 v[192:207], v[96:99], a[176:179], v[192:207]
    ds_read_b64_tr_b16 a[168:169], v146 offset:50176
    ds_read_b64_tr_b16 a[170:171], v146 offset:50432
    v_max_f32 v185, s58, v185
    v_exp_f32 v218, v218 clamp
    v_max_f32 v186, s58, v186
    v_exp_f32 v219, v219 clamp
    v_mfma_f32_32x32x16_bf16 v[192:207], v[100:103], a[180:183], v[192:207]
    ds_read_b64_tr_b16 a[172:173], v147 offset:50176
    ds_read_b64_tr_b16 a[174:175], v147 offset:50432
    v_max_f32 v187, s58, v187
    v_add_f32 v184, v184, v216
    v_add_f32 v185, v185, v217
    v_add_f32 v186, v186, v218
    v_add_f32 v187, v187, v219
    v_cvt_pk_bf16_f32 v212, v184, v185
    s_waitcnt lgkmcnt(8)
    v_mfma_f32_32x32x16_bf16 v[192:207], v[104:107], a[184:187], v[192:207]
    ds_read_b64_tr_b16 a[176:177], v144 offset:51200
    ds_read_b64_tr_b16 a[178:179], v144 offset:51456
    s_add_u32 m0, s53, 33792
    s_add_u32 s88, s66, 0
    buffer_load_dwordx4 v6, s[12:15], s88 offen lds
    v_cvt_pk_bf16_f32 v213, v186, v187
    v_fmac_f32 v188, v236, v164
    v_fmac_f32 v189, v237, v164
    v_fmac_f32 v190, v238, v164
    v_fmac_f32 v191, v239, v164
    v_fma_f32 v188, v188, v252, s58
    v_mfma_f32_32x32x16_bf16 v[192:207], v[108:111], a[188:191], v[192:207]
    ds_read_b64_tr_b16 a[180:181], v145 offset:51200
    ds_read_b64_tr_b16 a[182:183], v145 offset:51456
    v_fma_f32 v189, v189, v253, s58
    v_fma_f32 v190, v190, v254, s58
    v_fma_f32 v191, v191, v255, s58
    v_fma_f32 v220, v188, s56, v20
    v_fma_f32 v221, v189, s56, v20
    s_waitcnt lgkmcnt(8)
    v_mfma_f32_16x16x32_bf16 a[244:247], a[224:227], a[160:163], a[244:247]
    v_mfma_f32_32x32x16_bf16 v[192:207], v[112:115], a[160:163], v[192:207]
    ds_read_b64_tr_b16 a[184:185], v146 offset:51200
    ds_read_b64_tr_b16 a[186:187], v146 offset:51456
    v_fma_f32 v222, v190, s56, v20
    v_fma_f32 v223, v191, s56, v20
    v_exp_f32 v220, v220 clamp
    v_max_f32 v188, s58, v188
    v_mfma_f32_32x32x16_bf16 v[192:207], v[116:119], a[164:167], v[192:207]
    ds_read_b64_tr_b16 a[188:189], v147 offset:51200
    ds_read_b64_tr_b16 a[190:191], v147 offset:51456
    v_exp_f32 v221, v221 clamp
    v_max_f32 v189, s58, v189
    v_exp_f32 v222, v222 clamp
    v_max_f32 v190, s58, v190
    s_waitcnt lgkmcnt(8)
    v_mfma_f32_32x32x16_bf16 v[192:207], v[120:123], a[168:171], v[192:207]
    v_exp_f32 v223, v223 clamp
    v_max_f32 v191, s58, v191
    v_add_f32 v188, v188, v220
    v_add_f32 v189, v189, v221
    v_add_f32 v190, v190, v222
    v_mfma_f32_32x32x16_bf16 v[192:207], v[124:127], a[172:175], v[192:207]
    v_add_f32 v191, v191, v223
    v_cvt_pk_bf16_f32 v214, v188, v189
    v_cvt_pk_bf16_f32 v215, v190, v191
    ds_write_b128 v148, v[208:211]
    ds_write_b128 v148, v[212:215] offset:1024
    s_waitcnt lgkmcnt(6)
    v_mfma_f32_16x16x32_bf16 a[244:247], a[224:227], a[176:179], a[244:247]
    v_mfma_f32_32x32x16_bf16 v[192:207], v[128:131], a[176:179], v[192:207]
    s_add_u32 m0, s53, 34816
    s_add_u32 s88, s67, 0
    buffer_load_dwordx4 v6, s[12:15], s88 offen lds
    v_mfma_f32_32x32x16_bf16 v[192:207], v[132:135], a[180:183], v[192:207]
    buffer_load_dword v166, v175, s[36:39], s41 offen sc1
    s_waitcnt lgkmcnt(2)
    v_mfma_f32_32x32x16_bf16 v[192:207], v[136:139], a[184:187], v[192:207]
    ds_write_b32 v167, a244 offset:512
    v_mfma_f32_32x32x16_bf16 v[192:207], v[140:143], a[188:191], v[192:207]
    s_waitcnt lgkmcnt(0)
    s_barrier
    ds_read_b128 v[168:171], v172 offset:512
    ds_read_b128 v[176:179], v149
    ds_read_b128 v[180:183], v149 offset:4096
    ds_read_b128 v[184:187], v149 offset:8192
    ds_read_b128 v[188:191], v149 offset:12288
    s_add_u32 m0, s53, 35840
    s_add_u32 s88, s68, 0
    buffer_load_dwordx4 v6, s[12:15], s88 offen lds
    s_waitcnt lgkmcnt(4)
    v_add_f32 v168, v168, v169
    v_add_f32 v170, v170, v171
    v_add_f32 v164, v168, v170
    v_pk_fma_f32 v[192:193], v[224:225], v[164:165], v[192:193] op_sel:[0,0,0] op_sel_hi:[1,0,1] neg_lo:[1,0,0] neg_hi:[1,0,0]
    v_pk_fma_f32 v[194:195], v[226:227], v[164:165], v[194:195] op_sel:[0,0,0] op_sel_hi:[1,0,1] neg_lo:[1,0,0] neg_hi:[1,0,0]
    v_pk_fma_f32 v[196:197], v[228:229], v[164:165], v[196:197] op_sel:[0,0,0] op_sel_hi:[1,0,1] neg_lo:[1,0,0] neg_hi:[1,0,0]
    v_pk_fma_f32 v[198:199], v[230:231], v[164:165], v[198:199] op_sel:[0,0,0] op_sel_hi:[1,0,1] neg_lo:[1,0,0] neg_hi:[1,0,0]
    v_pk_mul_f32 v[192:193], v[192:193], v[240:241] op_sel:[0,0] op_sel_hi:[1,1]
    v_pk_mul_f32 v[194:195], v[194:195], v[242:243] op_sel:[0,0] op_sel_hi:[1,1]
    v_pk_mul_f32 v[196:197], v[196:197], v[244:245] op_sel:[0,0] op_sel_hi:[1,1]
    v_pk_mul_f32 v[198:199], v[198:199], v[246:247] op_sel:[0,0] op_sel_hi:[1,1]
    v_cvt_pk_bf16_f32 v216, v192, v193
    v_cvt_pk_bf16_f32 v217, v194, v195
    v_cvt_pk_bf16_f32 v218, v196, v197
    v_cvt_pk_bf16_f32 v219, v198, v199
    v_cndmask_b32 v216, v216, v21, vcc
    v_cndmask_b32 v217, v217, v21, vcc
    v_cndmask_b32 v218, v218, v21, vcc
    v_cndmask_b32 v219, v219, v21, vcc
    ds_write_b128 v148, v[216:219] offset:2048
    v_pk_fma_f32 v[200:201], v[232:233], v[164:165], v[200:201] op_sel:[0,0,0] op_sel_hi:[1,0,1] neg_lo:[1,0,0] neg_hi:[1,0,0]
    v_pk_fma_f32 v[202:203], v[234:235], v[164:165], v[202:203] op_sel:[0,0,0] op_sel_hi:[1,0,1] neg_lo:[1,0,0] neg_hi:[1,0,0]
    v_pk_fma_f32 v[204:205], v[236:237], v[164:165], v[204:205] op_sel:[0,0,0] op_sel_hi:[1,0,1] neg_lo:[1,0,0] neg_hi:[1,0,0]
    v_pk_fma_f32 v[206:207], v[238:239], v[164:165], v[206:207] op_sel:[0,0,0] op_sel_hi:[1,0,1] neg_lo:[1,0,0] neg_hi:[1,0,0]
    v_pk_mul_f32 v[200:201], v[200:201], v[248:249] op_sel:[0,0] op_sel_hi:[1,1]
    v_pk_mul_f32 v[202:203], v[202:203], v[250:251] op_sel:[0,0] op_sel_hi:[1,1]
    v_pk_mul_f32 v[204:205], v[204:205], v[252:253] op_sel:[0,0] op_sel_hi:[1,1]
    v_pk_mul_f32 v[206:207], v[206:207], v[254:255] op_sel:[0,0] op_sel_hi:[1,1]
    v_cvt_pk_bf16_f32 v220, v200, v201
    v_cvt_pk_bf16_f32 v221, v202, v203
    v_cvt_pk_bf16_f32 v222, v204, v205
    v_cvt_pk_bf16_f32 v223, v206, v207
    v_cndmask_b32 v220, v220, v21, vcc
    v_cndmask_b32 v221, v221, v21, vcc
    v_cndmask_b32 v222, v222, v21, vcc
    v_cndmask_b32 v223, v223, v21, vcc
    ds_write_b128 v148, v[220:223] offset:3072
    s_waitcnt lgkmcnt(0)
    s_barrier
    ds_read_b128 v[192:195], v159
    ds_read_b128 v[196:199], v159 offset:4096
    ds_read_b128 v[200:203], v159 offset:8192
    ds_read_b128 v[204:207], v159 offset:12288
    s_add_u32 m0, s53, 49152
    s_add_u32 s88, s69, 0
    buffer_load_dwordx4 v6, s[12:15], s88 offen lds
    s_waitcnt lgkmcnt(3)
    v_mfma_f32_16x16x32_bf16 v[208:211], v[176:179], v[192:195], 0
    s_waitcnt lgkmcnt(2)
    v_mfma_f32_16x16x32_bf16 v[208:211], v[180:183], v[196:199], v[208:211]
    s_waitcnt lgkmcnt(1)
    v_mfma_f32_16x16x32_bf16 v[208:211], v[184:187], v[200:203], v[208:211]
    s_waitcnt lgkmcnt(0)
    v_mfma_f32_16x16x32_bf16 v[208:211], v[188:191], v[204:207], v[208:211]
    s_nop 7
    v_cvt_pk_bf16_f32 v208, v208, v209
    v_cvt_pk_bf16_f32 v209, v210, v211
    buffer_store_dwordx2 v[208:209], v174, s[36:39], s60 offen sc1
    s_add_u32 m0, s53, 50176
    s_add_u32 s88, s70, 0
    buffer_load_dwordx4 v6, s[12:15], s88 offen lds
    s_add_u32 m0, s53, 51200
    s_add_u32 s88, s71, 0
    buffer_load_dwordx4 v6, s[12:15], s88 offen lds
    s_waitcnt vmcnt(5)
    v_cmp_ne_u32 vcc, s40, v166
    s_cbranch_vccnz L_cc_4
L_cb_5:
    s_waitcnt vmcnt(4)
    s_barrier
    ds_read_b64_tr_b16 a[160:161], v144
    ds_read_b64_tr_b16 a[162:163], v144 offset:256
    ds_read_b64_tr_b16 a[164:165], v145
    ds_read_b64_tr_b16 a[166:167], v145 offset:256
    ds_read_b64_tr_b16 a[168:169], v146
    ds_read_b64_tr_b16 a[170:171], v146 offset:256
    ds_read_b64_tr_b16 a[172:173], v147
    ds_read_b64_tr_b16 a[174:175], v147 offset:256
    ds_read_b64_tr_b16 a[176:177], v144 offset:1024
    ds_read_b64_tr_b16 a[178:179], v144 offset:1280
    ds_read_b64_tr_b16 a[180:181], v145 offset:1024
    ds_read_b64_tr_b16 a[182:183], v145 offset:1280
    v_mov_b32 v7, v160
    v_mov_b32 v8, v161
    v_xor_b32 v9, 16, v28
    v_xor_b32 v10, 32, v28
    v_xor_b32 v11, 48, v28
    s_waitcnt lgkmcnt(8)
    v_mfma_f32_16x16x32_bf16 a[240:243], a[224:227], a[160:163], 0
    v_mfma_f32_32x32x16_bf16 v[176:191], a[160:163], v[32:35], 0
    ds_read_b64_tr_b16 a[184:185], v146 offset:1024
    ds_read_b64_tr_b16 a[186:187], v146 offset:1280
    buffer_store_dwordx4 a[248:251], v15, s[36:39], s90 offen sc1
    v_mfma_f32_32x32x16_bf16 v[176:191], a[164:167], v[36:39], v[176:191]
    ds_read_b64_tr_b16 a[188:189], v147 offset:1024
    ds_read_b64_tr_b16 a[190:191], v147 offset:1280
    buffer_store_dwordx4 a[248:251], v15, s[36:39], s90 offen offset:1024 sc1
    s_waitcnt lgkmcnt(8)
    v_mfma_f32_32x32x16_bf16 v[176:191], a[168:171], v[40:43], v[176:191]
    ds_read_b64_tr_b16 a[160:161], v144 offset:2048
    ds_read_b64_tr_b16 a[162:163], v144 offset:2304
    s_mov_b64 exec, 0xffff
    buffer_store_dwordx4 a[248:251], v15, s[36:39], s63 offen sc1
    s_mov_b64 exec, -1
    v_mfma_f32_32x32x16_bf16 v[176:191], a[172:175], v[44:47], v[176:191]
    ds_read_b64_tr_b16 a[164:165], v145 offset:2048
    ds_read_b64_tr_b16 a[166:167], v145 offset:2304
    s_add_u32 m0, s53, 0
    s_nop 0
    buffer_load_dwordx4 v24, s[20:23], s95 offen lds
    buffer_load_dwordx4 v25, s[24:27], s95 offen offset:1024 lds
    s_waitcnt lgkmcnt(8)
    v_mfma_f32_16x16x32_bf16 a[240:243], a[224:227], a[176:179], a[240:243]
    v_mfma_f32_32x32x16_bf16 v[176:191], a[176:179], v[48:51], v[176:191]
    ds_read_b64_tr_b16 a[168:169], v146 offset:2048
    ds_read_b64_tr_b16 a[170:171], v146 offset:2304
    v_mfma_f32_32x32x16_bf16 v[176:191], a[180:183], v[52:55], v[176:191]
    ds_read_b64_tr_b16 a[172:173], v147 offset:2048
    ds_read_b64_tr_b16 a[174:175], v147 offset:2304
    s_waitcnt lgkmcnt(8)
    v_mfma_f32_32x32x16_bf16 v[176:191], a[184:187], v[56:59], v[176:191]
    ds_read_b64_tr_b16 a[176:177], v144 offset:3072
    ds_read_b64_tr_b16 a[178:179], v144 offset:3328
    s_add_u32 s65, s43, 4096
    v_mfma_f32_32x32x16_bf16 v[176:191], a[188:191], v[60:63], v[176:191]
    ds_read_b64_tr_b16 a[180:181], v145 offset:3072
    ds_read_b64_tr_b16 a[182:183], v145 offset:3328
    s_add_u32 m0, s53, 2048
    s_add_u32 s95, s95, 57344
    s_cmp_eq_u32 s95, 1605632
    s_cselect_b32 s95, 0, s95
    buffer_load_dwordx4 v24, s[20:23], s95 offen lds
    buffer_load_dwordx4 v25, s[24:27], s95 offen offset:1024 lds
    s_waitcnt lgkmcnt(8)
    v_mfma_f32_16x16x32_bf16 a[240:243], a[224:227], a[160:163], a[240:243]
    v_mfma_f32_32x32x16_bf16 v[176:191], a[160:163], v[64:67], v[176:191]
    ds_read_b64_tr_b16 a[184:185], v146 offset:3072
    ds_read_b64_tr_b16 a[186:187], v146 offset:3328
    v_mfma_f32_32x32x16_bf16 v[176:191], a[164:167], v[68:71], v[176:191]
    ds_read_b64_tr_b16 a[188:189], v147 offset:3072
    ds_read_b64_tr_b16 a[190:191], v147 offset:3328
    s_mul_i32 s6, s87, 28672
    s_waitcnt vmcnt(8)
    s_barrier
    s_waitcnt lgkmcnt(8)
    v_mfma_f32_32x32x16_bf16 v[176:191], a[168:171], v[72:75], v[176:191]
    ds_read_b64_tr_b16 a[160:161], v144 offset:16384
    ds_read_b64_tr_b16 a[162:163], v144 offset:16640
    v_mfma_f32_32x32x16_bf16 v[176:191], a[172:175], v[76:79], v[176:191]
    ds_read_b64_tr_b16 a[164:165], v145 offset:16384
    ds_read_b64_tr_b16 a[166:167], v145 offset:16640
    s_add_u32 m0, s53, 16384
    s_add_u32 s95, s95, 57344
    s_cmp_eq_u32 s95, 1605632
    s_cselect_b32 s95, 0, s95
    buffer_load_dwordx4 v24, s[20:23], s95 offen lds
    buffer_load_dwordx4 v25, s[24:27], s95 offen offset:1024 lds
    s_waitcnt lgkmcnt(8)
    v_mfma_f32_16x16x32_bf16 a[240:243], a[224:227], a[176:179], a[240:243]
    v_mfma_f32_32x32x16_bf16 v[176:191], a[176:179], v[80:83], v[176:191]
    ds_read_b64_tr_b16 a[168:169], v146 offset:16384
    ds_read_b64_tr_b16 a[170:171], v146 offset:16640
    v_mfma_f32_32x32x16_bf16 v[176:191], a[180:183], v[84:87], v[176:191]
    ds_read_b64_tr_b16 a[172:173], v147 offset:16384
    ds_read_b64_tr_b16 a[174:175], v147 offset:16640
    s_waitcnt lgkmcnt(8)
    v_mfma_f32_32x32x16_bf16 v[176:191], a[184:187], v[88:91], v[176:191]
    ds_read_b64_tr_b16 a[176:177], v144 offset:17408
    ds_read_b64_tr_b16 a[178:179], v144 offset:17664
    v_mfma_f32_32x32x16_bf16 v[176:191], a[188:191], v[92:95], v[176:191]
    ds_read_b64_tr_b16 a[180:181], v145 offset:17408
    ds_read_b64_tr_b16 a[182:183], v145 offset:17664
    s_waitcnt lgkmcnt(8)
    v_mfma_f32_16x16x32_bf16 a[240:243], a[224:227], a[160:163], a[240:243]
    v_mfma_f32_32x32x16_bf16 v[176:191], a[160:163], v[96:99], v[176:191]
    ds_read_b64_tr_b16 a[184:185], v146 offset:17408
    ds_read_b64_tr_b16 a[186:187], v146 offset:17664
    v_mfma_f32_32x32x16_bf16 v[176:191], a[164:167], v[100:103], v[176:191]
    ds_read_b64_tr_b16 a[188:189], v147 offset:17408
    ds_read_b64_tr_b16 a[190:191], v147 offset:17664
    s_waitcnt vmcnt(9)
    s_barrier
    s_waitcnt lgkmcnt(8)
    v_mfma_f32_32x32x16_bf16 v[176:191], a[168:171], v[104:107], v[176:191]
    ds_read_b64_tr_b16 a[160:161], v144 offset:18432
    ds_read_b64_tr_b16 a[162:163], v144 offset:18688
    v_mfma_f32_32x32x16_bf16 v[176:191], a[172:175], v[108:111], v[176:191]
    ds_read_b64_tr_b16 a[164:165], v145 offset:18432
    ds_read_b64_tr_b16 a[166:167], v145 offset:18688
    s_waitcnt lgkmcnt(8)
    v_mfma_f32_16x16x32_bf16 a[240:243], a[224:227], a[176:179], a[240:243]
    v_mfma_f32_32x32x16_bf16 v[176:191], a[176:179], v[112:115], v[176:191]
    ds_read_b64_tr_b16 a[168:169], v146 offset:18432
    ds_read_b64_tr_b16 a[170:171], v146 offset:18688
    v_mfma_f32_32x32x16_bf16 v[176:191], a[180:183], v[116:119], v[176:191]
    ds_read_b64_tr_b16 a[172:173], v147 offset:18432
    ds_read_b64_tr_b16 a[174:175], v147 offset:18688
    s_waitcnt lgkmcnt(8)
    v_mfma_f32_32x32x16_bf16 v[176:191], a[184:187], v[120:123], v[176:191]
    v_mfma_f32_32x32x16_bf16 v[176:191], a[188:191], v[124:127], v[176:191]
    s_waitcnt lgkmcnt(4)
    v_mfma_f32_16x16x32_bf16 a[240:243], a[224:227], a[160:163], a[240:243]
    v_mfma_f32_32x32x16_bf16 v[176:191], a[160:163], v[128:131], v[176:191]
    v_mfma_f32_32x32x16_bf16 v[176:191], a[164:167], v[132:135], v[176:191]
    s_waitcnt lgkmcnt(0)
    v_mfma_f32_32x32x16_bf16 v[176:191], a[168:171], v[136:139], v[176:191]
    s_nop 3
    ds_write_b32 v167, a240 offset:1024
    v_mfma_f32_32x32x16_bf16 v[176:191], a[172:175], v[140:143], v[176:191]
    s_waitcnt lgkmcnt(0)
    s_barrier
    ds_read_b128 v[168:171], v172 offset:1024
    buffer_load_dwordx4 v[224:227], v15, s[36:39], s43 offen sc1
    buffer_load_dwordx4 v[228:231], v15, s[36:39], s43 offen offset:1024 sc1
    buffer_load_dwordx4 v[232:235], v15, s[36:39], s43 offen offset:2048 sc1
    buffer_load_dwordx4 v[236:239], v15, s[36:39], s43 offen offset:3072 sc1
    s_waitcnt lgkmcnt(0)
    v_add_f32 v168, v168, v169
    v_add_f32 v170, v170, v171
    v_add_f32 v168, v168, v170
    ds_write_b32 v173, v168
    ds_read_b128 v[192:195], v30
    ds_read_b128 v[196:199], v30 offset:32
    ds_read_b128 v[200:203], v30 offset:64
    ds_read_b128 v[204:207], v30 offset:96
    buffer_load_dwordx4 v[240:243], v15, s[36:39], s65 offen sc1
    buffer_load_dwordx4 v[244:247], v15, s[36:39], s65 offen offset:1024 sc1
    buffer_load_dwordx4 v[248:251], v15, s[36:39], s65 offen offset:2048 sc1
    buffer_load_dwordx4 v[252:255], v15, s[36:39], s65 offen offset:3072 sc1
    s_waitcnt lgkmcnt(0)
    v_pk_fma_f32 v[176:177], v[18:19], v[192:193], v[176:177] op_sel:[0,0,0] op_sel_hi:[0,1,1] neg_lo:[1,0,0] neg_hi:[1,0,0]
    v_pk_fma_f32 v[178:179], v[18:19], v[194:195], v[178:179] op_sel:[0,0,0] op_sel_hi:[0,1,1] neg_lo:[1,0,0] neg_hi:[1,0,0]
    v_pk_fma_f32 v[180:181], v[18:19], v[196:197], v[180:181] op_sel:[0,0,0] op_sel_hi:[0,1,1] neg_lo:[1,0,0] neg_hi:[1,0,0]
    v_pk_fma_f32 v[182:183], v[18:19], v[198:199], v[182:183] op_sel:[0,0,0] op_sel_hi:[0,1,1] neg_lo:[1,0,0] neg_hi:[1,0,0]
    v_pk_fma_f32 v[184:185], v[18:19], v[200:201], v[184:185] op_sel:[0,0,0] op_sel_hi:[0,1,1] neg_lo:[1,0,0] neg_hi:[1,0,0]
    v_pk_fma_f32 v[186:187], v[18:19], v[202:203], v[186:187] op_sel:[0,0,0] op_sel_hi:[0,1,1] neg_lo:[1,0,0] neg_hi:[1,0,0]
    v_pk_fma_f32 v[188:189], v[18:19], v[204:205], v[188:189] op_sel:[0,0,0] op_sel_hi:[0,1,1] neg_lo:[1,0,0] neg_hi:[1,0,0]
    v_pk_fma_f32 v[190:191], v[18:19], v[206:207], v[190:191] op_sel:[0,0,0] op_sel_hi:[0,1,1] neg_lo:[1,0,0] neg_hi:[1,0,0]
    v_pk_mul_f32 v[176:177], v[176:177], v[18:19] op_sel:[0,1] op_sel_hi:[1,1]
    v_pk_mul_f32 v[178:179], v[178:179], v[18:19] op_sel:[0,1] op_sel_hi:[1,1]
    v_pk_mul_f32 v[180:181], v[180:181], v[18:19] op_sel:[0,1] op_sel_hi:[1,1]
    v_pk_mul_f32 v[182:183], v[182:183], v[18:19] op_sel:[0,1] op_sel_hi:[1,1]
    v_pk_mul_f32 v[184:185], v[184:185], v[18:19] op_sel:[0,1] op_sel_hi:[1,1]
    v_pk_mul_f32 v[186:187], v[186:187], v[18:19] op_sel:[0,1] op_sel_hi:[1,1]
    v_pk_mul_f32 v[188:189], v[188:189], v[18:19] op_sel:[0,1] op_sel_hi:[1,1]
    v_pk_mul_f32 v[190:191], v[190:191], v[18:19] op_sel:[0,1] op_sel_hi:[1,1]
    v_pk_mul_f32 v[208:209], v[176:177], s[56:57]
    v_pk_mul_f32 v[210:211], v[178:179], s[56:57]
    v_pk_mul_f32 v[212:213], v[180:181], s[56:57]
    v_pk_mul_f32 v[214:215], v[182:183], s[56:57]
    v_pk_mul_f32 v[216:217], v[184:185], s[56:57]
    v_pk_mul_f32 v[218:219], v[186:187], s[56:57]
    v_pk_mul_f32 v[220:221], v[188:189], s[56:57]
    v_pk_mul_f32 v[222:223], v[190:191], s[56:57]
    v_exp_f32 v208, v208 clamp
    v_max_f32 v176, 0, v176
    v_exp_f32 v209, v209 clamp
    v_max_f32 v177, 0, v177
    v_exp_f32 v210, v210 clamp
    v_max_f32 v178, 0, v178
    v_exp_f32 v211, v211 clamp
    v_max_f32 v179, 0, v179
    v_exp_f32 v212, v212 clamp
    v_max_f32 v180, 0, v180
    v_exp_f32 v213, v213 clamp
    v_max_f32 v181, 0, v181
    v_exp_f32 v214, v214 clamp
    v_max_f32 v182, 0, v182
    v_exp_f32 v215, v215 clamp
    v_max_f32 v183, 0, v183
    v_exp_f32 v216, v216 clamp
    v_max_f32 v184, 0, v184
    v_exp_f32 v217, v217 clamp
    v_max_f32 v185, 0, v185
    v_exp_f32 v218, v218 clamp
    v_max_f32 v186, 0, v186
    v_exp_f32 v219, v219 clamp
    v_max_f32 v187, 0, v187
    v_exp_f32 v220, v220 clamp
    v_max_f32 v188, 0, v188
    v_exp_f32 v221, v221 clamp
    v_max_f32 v189, 0, v189
    v_exp_f32 v222, v222 clamp
    v_max_f32 v190, 0, v190
    v_exp_f32 v223, v223 clamp
    v_max_f32 v191, 0, v191
    v_pk_add_f32 v[176:177], v[176:177], v[208:209]
    v_pk_add_f32 v[178:179], v[178:179], v[210:211]
    v_pk_add_f32 v[180:181], v[180:181], v[212:213]
    v_pk_add_f32 v[182:183], v[182:183], v[214:215]
    v_pk_add_f32 v[184:185], v[184:185], v[216:217]
    v_pk_add_f32 v[186:187], v[186:187], v[218:219]
    v_pk_add_f32 v[188:189], v[188:189], v[220:221]
    v_pk_add_f32 v[190:191], v[190:191], v[222:223]
    v_pk_add_f32 v[176:177], v[176:177], s[58:59]
    v_pk_add_f32 v[178:179], v[178:179], s[58:59]
    v_pk_add_f32 v[180:181], v[180:181], s[58:59]
    v_pk_add_f32 v[182:183], v[182:183], s[58:59]
    v_pk_add_f32 v[184:185], v[184:185], s[58:59]
    v_pk_add_f32 v[186:187], v[186:187], s[58:59]
    v_pk_add_f32 v[188:189], v[188:189], s[58:59]
    v_pk_add_f32 v[190:191], v[190:191], s[58:59]
    v_cvt_pk_bf16_f32 v160, v176, v177
    v_cvt_pk_bf16_f32 v161, v178, v179
    v_cvt_pk_bf16_f32 v162, v180, v181
    v_cvt_pk_bf16_f32 v163, v182, v183
    v_cvt_pk_bf16_f32 v164, v184, v185
    v_cvt_pk_bf16_f32 v165, v186, v187
    v_cvt_pk_bf16_f32 v166, v188, v189
    v_cvt_pk_bf16_f32 v167, v190, v191
    v_cndmask_b32 v166, v166, 0, s[0:1]
    v_cndmask_b32 v167, v167, 0, s[0:1]
    s_lshl4_add_u32 m0, s72, s96
    s_mul_i32 s88, s72, 112
    s_add_u32 s88, s88, s92
    buffer_load_dwordx4 v16, s[16:19], s88 offen lds
    buffer_load_dwordx4 v17, s[16:19], s88 offen offset:1024 lds
    s_lshl4_add_u32 m0, s73, s96
    s_mul_i32 s88, s73, 112
    s_add_u32 s88, s88, s92
    buffer_load_dwordx4 v16, s[16:19], s88 offen lds
    buffer_load_dwordx4 v17, s[16:19], s88 offen offset:1024 lds
    s_lshl4_add_u32 m0, s74, s96
    s_mul_i32 s88, s74, 112
    s_add_u32 s88, s88, s92
    buffer_load_dwordx4 v16, s[16:19], s88 offen lds
    buffer_load_dwordx4 v17, s[16:19], s88 offen offset:1024 lds
    s_lshl4_add_u32 m0, s75, s96
    s_mul_i32 s88, s75, 112
    s_add_u32 s88, s88, s92
    buffer_load_dwordx4 v16, s[16:19], s88 offen lds
    buffer_load_dwordx4 v17, s[16:19], s88 offen offset:1024 lds
    s_lshl4_add_u32 m0, s76, s96
    s_mul_i32 s88, s76, 112
    s_add_u32 s88, s88, s92
    buffer_load_dwordx4 v16, s[16:19], s88 offen lds
    buffer_load_dwordx4 v17, s[16:19], s88 offen offset:1024 lds
R_top_6:
    v_mov_b32 v168, 0
    v_mov_b32 v169, 0
    v_mov_b32 v170, 0
    v_mov_b32 v171, 0
    v_mov_b32 v172, 0
    v_mov_b32 v173, 0
    v_mov_b32 v174, 0
    v_mov_b32 v175, 0
    s_waitcnt vmcnt(17)
    v_dot2c_f32_bf16 v168, s98, v224
    v_dot2c_f32_bf16 v169, s99, v224
    v_dot2c_f32_bf16 v170, s98, v225
    v_dot2c_f32_bf16 v171, s99, v225
    v_dot2c_f32_bf16 v172, s98, v226
    v_dot2c_f32_bf16 v173, s99, v226
    v_dot2c_f32_bf16 v174, s98, v227
    v_dot2c_f32_bf16 v175, s99, v227
    s_waitcnt vmcnt(16)
    v_dot2c_f32_bf16 v168, s98, v228
    v_dot2c_f32_bf16 v169, s99, v228
    v_dot2c_f32_bf16 v170, s98, v229
    v_dot2c_f32_bf16 v171, s99, v229
    v_dot2c_f32_bf16 v172, s98, v230
    v_dot2c_f32_bf16 v173, s99, v230
    v_dot2c_f32_bf16 v174, s98, v231
    v_dot2c_f32_bf16 v175, s99, v231
    s_waitcnt vmcnt(15)
    v_dot2c_f32_bf16 v168, s98, v232
    v_dot2c_f32_bf16 v169, s99, v232
    v_dot2c_f32_bf16 v170, s98, v233
    v_dot2c_f32_bf16 v171, s99, v233
    v_dot2c_f32_bf16 v172, s98, v234
    v_dot2c_f32_bf16 v173, s99, v234
    v_dot2c_f32_bf16 v174, s98, v235
    v_dot2c_f32_bf16 v175, s99, v235
    s_waitcnt vmcnt(14)
    v_dot2c_f32_bf16 v168, s98, v236
    v_dot2c_f32_bf16 v169, s99, v236
    v_dot2c_f32_bf16 v170, s98, v237
    v_dot2c_f32_bf16 v171, s99, v237
    v_dot2c_f32_bf16 v172, s98, v238
    v_dot2c_f32_bf16 v173, s99, v238
    v_dot2c_f32_bf16 v174, s98, v239
    v_dot2c_f32_bf16 v175, s99, v239
    s_waitcnt vmcnt(13)
    v_dot2c_f32_bf16 v168, s98, v240
    v_dot2c_f32_bf16 v169, s99, v240
    v_dot2c_f32_bf16 v170, s98, v241
    v_dot2c_f32_bf16 v171, s99, v241
    v_dot2c_f32_bf16 v172, s98, v242
    v_dot2c_f32_bf16 v173, s99, v242
    v_dot2c_f32_bf16 v174, s98, v243
    v_dot2c_f32_bf16 v175, s99, v243
    s_waitcnt vmcnt(12)
    v_dot2c_f32_bf16 v168, s98, v244
    v_dot2c_f32_bf16 v169, s99, v244
    v_dot2c_f32_bf16 v170, s98, v245
    v_dot2c_f32_bf16 v171, s99, v245
    v_dot2c_f32_bf16 v172, s98, v246
    v_dot2c_f32_bf16 v173, s99, v246
    v_dot2c_f32_bf16 v174, s98, v247
    v_dot2c_f32_bf16 v175, s99, v247
    s_waitcnt vmcnt(11)
    v_dot2c_f32_bf16 v168, s98, v248
    v_dot2c_f32_bf16 v169, s99, v248
    v_dot2c_f32_bf16 v170, s98, v249
    v_dot2c_f32_bf16 v171, s99, v249
    v_dot2c_f32_bf16 v172, s98, v250
    v_dot2c_f32_bf16 v173, s99, v250
    v_dot2c_f32_bf16 v174, s98, v251
    v_dot2c_f32_bf16 v175, s99, v251
    s_waitcnt vmcnt(10)
    v_dot2c_f32_bf16 v168, s98, v252
    v_dot2c_f32_bf16 v169, s99, v252
    v_dot2c_f32_bf16 v170, s98, v253
    v_dot2c_f32_bf16 v171, s99, v253
    v_dot2c_f32_bf16 v172, s98, v254
    v_dot2c_f32_bf16 v173, s99, v254
    v_dot2c_f32_bf16 v174, s98, v255
    v_dot2c_f32_bf16 v175, s99, v255
    v_permlane32_swap_b32 v168, v172
    v_permlane32_swap_b32 v169, v173
    v_permlane32_swap_b32 v170, v174
    v_permlane32_swap_b32 v171, v175
    v_pk_add_f32 v[168:169], v[168:169], v[172:173]
    v_pk_add_f32 v[170:171], v[170:171], v[174:175]
    v_cmp_u_f32 vcc, v168, v170
    v_cvt_pk_bf16_f32 v168, v168, v169
    v_cvt_pk_bf16_f32 v169, v170, v171
    s_cbranch_vccnz R_ool_7
R_done_8:
    ds_write_b64 v157, v[168:169]
    s_lshl4_add_u32 m0, s77, s96
    s_mul_i32 s88, s77, 112
    s_add_u32 s88, s88, s92
    buffer_load_dwordx4 v16, s[16:19], s88 offen lds
    buffer_load_dwordx4 v17, s[16:19], s88 offen offset:1024 lds
    s_waitcnt lgkmcnt(0)
    s_barrier
    ds_read_b128 v[208:211], v158
    ds_read_b128 v[212:215], v158 offset:1024
    s_lshl4_add_u32 m0, s78, s96
    s_mul_i32 s88, s78, 112
    s_add_u32 s88, s88, s92
    buffer_load_dwordx4 v16, s[16:19], s88 offen lds
    buffer_load_dwordx4 v17, s[16:19], s88 offen offset:1024 lds
    s_waitcnt lgkmcnt(1)
    v_mfma_f32_32x32x16_bf16 v[176:191], v[208:211], v[160:163], 0
    s_waitcnt lgkmcnt(0)
    v_mfma_f32_32x32x16_bf16 v[176:191], v[212:215], v[164:167], v[176:191]
    s_nop 11
    v_add_f32 v20, s58, v190
    v_rcp_f32 v20, v20
    s_nop 0
    v_pk_mul_f32 v[176:177], v[176:177], v[20:21] op_sel_hi:[1,0]
    v_pk_mul_f32 v[178:179], v[178:179], v[20:21] op_sel_hi:[1,0]
    v_pk_mul_f32 v[180:181], v[180:181], v[20:21] op_sel_hi:[1,0]
    v_pk_mul_f32 v[182:183], v[182:183], v[20:21] op_sel_hi:[1,0]
    v_cvt_pk_bf16_f32 v160, v176, v177
    v_cvt_pk_bf16_f32 v161, v178, v179
    v_cvt_pk_bf16_f32 v162, v180, v181
    v_cvt_pk_bf16_f32 v163, v182, v183
    buffer_store_dwordx4 v[160:163], v15, s[36:39], s61 offen sc1
    v_pk_mul_f32 v[184:185], v[184:185], v[20:21] op_sel_hi:[1,0]
    v_pk_mul_f32 v[186:187], v[186:187], v[20:21] op_sel_hi:[1,0]
    v_pk_mul_f32 v[188:189], v[188:189], v[20:21] op_sel_hi:[1,0]
    v_cvt_pk_bf16_f32 v164, v184, v185
    v_cvt_pk_bf16_f32 v165, v186, v187
    v_cvt_pk_bf16_f32 v166, v188, v189
    v_add3_u32 v167, v160, v161, s40
    v_add3_u32 v167, v167, v162, v163
    v_add3_u32 v167, v167, v164, v165
    v_add_u32 v167, v167, v166
    buffer_store_dwordx4 v[164:167], v15, s[36:39], s61 offen offset:1024 sc1
    s_bitcmp1_b32 s49, 8
    s_cbranch_scc1 L_helper
    v_lshrrev_b32 v6, 1, v15
    s_lshl_b32 s88, s3, 11
    s_add_u32 m0, s88, 151552
    s_nop 0
    buffer_load_dwordx4 v7, s[8:11], s52 offen lds
    buffer_load_dwordx4 v8, s[8:11], s52 offen offset:1024 lds
    s_add_u32 m0, s53, 18432
    s_add_u32 s95, s95, 57344
    s_cmp_eq_u32 s95, 1605632
    s_cselect_b32 s95, 0, s95
    buffer_load_dwordx4 v24, s[20:23], s95 offen lds
    buffer_load_dwordx4 v25, s[24:27], s95 offen offset:1024 lds
    v_add_u32 v22, s53, v15
    v_add_u32 v22, 131072, v22
    v_xor_b32 v23, 4096, v22
    s_waitcnt vmcnt(2)
    s_barrier
    buffer_load_dwordx4 v[160:163], v15, s[36:39], s79 offen sc1
    ds_read_b64 v[240:241], v28
    ds_read_b64 v[242:243], v9
    ds_read_b64 v[244:245], v10
    ds_read_b64 v[246:247], v11
    ds_read_b64_tr_b16 v[32:33], v2
    ds_read_b64_tr_b16 v[34:35], v2 offset:1024
    ds_read_b64_tr_b16 v[36:37], v3
    ds_read_b64_tr_b16 v[38:39], v3 offset:1024
    ds_read_b64_tr_b16 v[40:41], v2 offset:2048
    buffer_load_dwordx4 v[164:167], v15, s[36:39], s79 offen offset:1024 sc1
    ds_read_b64_tr_b16 v[42:43], v4 offset:3072
    ds_read_b64_tr_b16 v[44:45], v3 offset:2048
    ds_read_b64_tr_b16 v[46:47], v5 offset:3072
    v_subrev_u32 v2, s6, v2
    v_subrev_u32 v3, s6, v3
    v_subrev_u32 v4, s6, v4
    v_subrev_u32 v5, s6, v5
    ds_read_b64_tr_b16 v[48:49], v2 offset:3584
    ds_read_b64_tr_b16 v[50:51], v2 offset:4608
    buffer_load_dwordx4 v[168:171], v15, s[36:39], s80 offen sc1
    ds_read_b64_tr_b16 v[52:53], v3 offset:3584
    ds_read_b64_tr_b16 v[54:55], v3 offset:4608
    ds_read_b64_tr_b16 v[56:57], v2 offset:5632
    ds_read_b64_tr_b16 v[58:59], v4 offset:6656
    ds_read_b64_tr_b16 v[60:61], v3 offset:5632
    ds_read_b64_tr_b16 v[62:63], v5 offset:6656
    buffer_load_dwordx4 v[172:175], v15, s[36:39], s80 offen offset:1024 sc1
    ds_read_b64_tr_b16 v[64:65], v2 offset:10752
    ds_read_b64_tr_b16 v[66:67], v2 offset:11776
    ds_read_b64_tr_b16 v[68:69], v3 offset:10752
    ds_read_b64_tr_b16 v[70:71], v3 offset:11776
    ds_read_b64_tr_b16 v[72:73], v2 offset:12800
    ds_read_b64_tr_b16 v[74:75], v4 offset:13824
    ds_read_b64_tr_b16 v[76:77], v3 offset:12800
    buffer_load_dwordx4 v[176:179], v15, s[36:39], s81 offen sc1
    ds_read_b64_tr_b16 v[78:79], v5 offset:13824
    ds_read_b64_tr_b16 v[80:81], v2 offset:17920
    ds_read_b64_tr_b16 v[82:83], v2 offset:18944
    ds_read_b64_tr_b16 v[84:85], v3 offset:17920
    ds_read_b64_tr_b16 v[86:87], v3 offset:18944
    ds_read_b64_tr_b16 v[88:89], v2 offset:19968
    buffer_load_dwordx4 v[180:183], v15, s[36:39], s81 offen offset:1024 sc1
    ds_read_b64_tr_b16 v[90:91], v4 offset:20992
    ds_read_b64_tr_b16 v[92:93], v3 offset:19968
    ds_read_b64_tr_b16 v[94:95], v5 offset:20992
    ds_read_b64_tr_b16 v[96:97], v2 offset:25088
    ds_read_b64_tr_b16 v[98:99], v2 offset:26112
    ds_read_b64_tr_b16 v[100:101], v3 offset:25088
    ds_read_b64_tr_b16 v[102:103], v3 offset:26112
    buffer_load_dwordx4 v[184:187], v15, s[36:39], s82 offen sc1
    ds_read_b64_tr_b16 v[104:105], v2 offset:27136
    ds_read_b64_tr_b16 v[106:107], v4 offset:28160
    ds_read_b64_tr_b16 v[108:109], v3 offset:27136
    ds_read_b64_tr_b16 v[110:111], v5 offset:28160
    s_waitcnt lgkmcnt(15)
    v_lshlrev_b32 v224, 16, v240
    v_and_b32 v225, 0xffff0000, v240
    v_lshlrev_b32 v226, 16, v241
    buffer_load_dwordx4 v[188:191], v15, s[36:39], s82 offen offset:1024 sc1
    v_and_b32 v227, 0xffff0000, v241
    v_lshlrev_b32 v228, 16, v242
    v_and_b32 v229, 0xffff0000, v242
    v_lshlrev_b32 v230, 16, v243
    v_and_b32 v231, 0xffff0000, v243
    v_lshlrev_b32 v232, 16, v244
    v_and_b32 v233, 0xffff0000, v244
    v_lshlrev_b32 v234, 16, v245
    v_and_b32 v235, 0xffff0000, v245
    v_lshlrev_b32 v236, 16, v246
    v_and_b32 v237, 0xffff0000, v246
    v_lshlrev_b32 v238, 16, v247
    v_and_b32 v239, 0xffff0000, v247
    buffer_load_dwordx4 v[192:195], v15, s[36:39], s83 offen sc1
    buffer_load_dwordx4 v[196:199], v15, s[36:39], s83 offen offset:1024 sc1
    s_waitcnt lgkmcnt(0)
    s_waitcnt vmcnt(8)
    v_add3_u32 v20, v160, v161, s40
    v_add3_u32 v20, v20, v162, v163
    v_add3_u32 v20, v20, v164, v165
    v_add_u32 v20, v20, v166
    v_cmp_ne_u32 vcc, v167, v20
    s_cbranch_vccnz S_ool_19
S_bk_20:
    v_mov_b32 v167, 0
    v_mfma_f32_32x32x16_bf16 v[240:255], v[36:39], v[160:163], 0
    buffer_load_dwordx4 v[200:203], v15, s[36:39], s84 offen sc1
    ds_read_b64_tr_b16 v[112:113], v2 offset:7168
    ds_read_b64_tr_b16 v[114:115], v2 offset:8192
    v_mfma_f32_32x32x16_bf16 v[224:239], v[32:35], v[160:163], v[224:239]
    ds_read_b64_tr_b16 v[116:117], v3 offset:7168
    ds_read_b64_tr_b16 v[118:119], v3 offset:8192
    s_waitcnt vmcnt(7)
    v_add3_u32 v20, v168, v169, s40
    v_add3_u32 v20, v20, v170, v171
    v_mfma_f32_32x32x16_bf16 v[240:255], v[44:47], v[164:167], v[240:255]
    buffer_load_dwordx4 v[204:207], v15, s[36:39], s84 offen offset:1024 sc1
    ds_read_b64_tr_b16 v[120:121], v2 offset:9216
    ds_read_b64_tr_b16 v[122:123], v4 offset:10240
    v_add3_u32 v20, v20, v172, v173
    v_add_u32 v20, v20, v174
    v_mfma_f32_32x32x16_bf16 v[224:239], v[40:43], v[164:167], v[224:239]
    ds_read_b64_tr_b16 v[124:125], v3 offset:9216
    v_cmp_ne_u32 vcc, v175, v20
    s_cbranch_vccnz S_ool_26
S_bk_27:
    v_mov_b32 v175, 0
    v_mfma_f32_32x32x16_bf16 v[240:255], v[52:55], v[168:171], v[240:255]
    buffer_load_dwordx4 v[208:211], v15, s[36:39], s85 offen sc1
    ds_read_b64_tr_b16 v[126:127], v5 offset:10240
    ds_read_b64_tr_b16 v[128:129], v2 offset:14336
    v_mfma_f32_32x32x16_bf16 v[224:239], v[48:51], v[168:171], v[224:239]
    ds_read_b64_tr_b16 v[130:131], v2 offset:15360
    ds_read_b64_tr_b16 v[132:133], v3 offset:14336
    s_waitcnt vmcnt(7)
    v_add3_u32 v20, v176, v177, s40
    v_add3_u32 v20, v20, v178, v179
    v_mfma_f32_32x32x16_bf16 v[240:255], v[60:63], v[172:175], v[240:255]
    buffer_load_dwordx4 v[212:215], v15, s[36:39], s85 offen offset:1024 sc1
    ds_read_b64_tr_b16 v[134:135], v3 offset:15360
    v_add3_u32 v20, v20, v180, v181
    v_add_u32 v20, v20, v182
    v_mfma_f32_32x32x16_bf16 v[224:239], v[56:59], v[172:175], v[224:239]
    ds_read_b64_tr_b16 v[136:137], v2 offset:16384
    ds_read_b64_tr_b16 v[138:139], v4 offset:17408
    v_cmp_ne_u32 vcc, v183, v20
    s_cbranch_vccnz S_ool_32
S_bk_33:
    v_mov_b32 v183, 0
    v_mfma_f32_32x32x16_bf16 v[240:255], v[68:71], v[176:179], v[240:255]
    buffer_load_dwordx4 v[216:219], v15, s[36:39], s86 offen sc1
    ds_read_b64_tr_b16 v[140:141], v3 offset:16384
    ds_read_b64_tr_b16 v[142:143], v5 offset:17408
    v_mfma_f32_32x32x16_bf16 v[224:239], v[64:67], v[176:179], v[224:239]
    ds_read_b64_tr_b16 v[144:145], v2 offset:21504
    ds_read_b64_tr_b16 v[146:147], v2 offset:22528
    s_waitcnt vmcnt(7)
    v_add3_u32 v20, v184, v185, s40
    v_add3_u32 v20, v20, v186, v187
    v_mfma_f32_32x32x16_bf16 v[240:255], v[76:79], v[180:183], v[240:255]
    buffer_load_dwordx4 v[220:223], v15, s[36:39], s86 offen offset:1024 sc1
    ds_read_b64_tr_b16 v[148:149], v3 offset:21504
    v_add3_u32 v20, v20, v188, v189
    v_add_u32 v20, v20, v190
    v_mfma_f32_32x32x16_bf16 v[224:239], v[72:75], v[180:183], v[224:239]
    ds_read_b64_tr_b16 v[150:151], v3 offset:22528
    ds_read_b64_tr_b16 v[152:153], v2 offset:23552
    v_cmp_ne_u32 vcc, v191, v20
    s_cbranch_vccnz S_ool_37
S_bk_38:
    v_mov_b32 v191, 0
    v_mfma_f32_32x32x16_bf16 v[240:255], v[84:87], v[184:187], v[240:255]
    s_add_u32 m0, s53, 32768
    s_add_u32 s95, s95, 57344
    s_cmp_eq_u32 s95, 1605632
    s_cselect_b32 s95, 0, s95
    buffer_load_dwordx4 v24, s[20:23], s95 offen lds
    buffer_load_dwordx4 v25, s[24:27], s95 offen offset:1024 lds
    v_mfma_f32_32x32x16_bf16 v[224:239], v[80:83], v[184:187], v[224:239]
    ds_read_b64_tr_b16 v[154:155], v4 offset:24576
    ds_read_b64_tr_b16 v[156:157], v3 offset:23552
    ds_read_b64_tr_b16 v[158:159], v5 offset:24576
    s_waitcnt vmcnt(8)
    v_add3_u32 v20, v192, v193, s40
    v_mfma_f32_32x32x16_bf16 v[240:255], v[92:95], v[188:191], v[240:255]
    v_add3_u32 v20, v20, v194, v195
    v_add3_u32 v20, v20, v196, v197
    v_add_u32 v20, v20, v198
    v_mfma_f32_32x32x16_bf16 v[224:239], v[88:91], v[188:191], v[224:239]
    v_cmp_ne_u32 vcc, v199, v20
    s_cbranch_vccnz S_ool_41
S_bk_42:
    v_mov_b32 v199, 0
    v_mfma_f32_32x32x16_bf16 v[240:255], v[100:103], v[192:195], v[240:255]
    v_mfma_f32_32x32x16_bf16 v[224:239], v[96:99], v[192:195], v[224:239]
    s_add_u32 m0, s53, 34816
    s_add_u32 s95, s95, 57344
    s_cmp_eq_u32 s95, 1605632
    s_cselect_b32 s95, 0, s95
    buffer_load_dwordx4 v24, s[20:23], s95 offen lds
    buffer_load_dwordx4 v25, s[24:27], s95 offen offset:1024 lds
    v_mfma_f32_32x32x16_bf16 v[240:255], v[108:111], v[196:199], v[240:255]
    s_waitcnt vmcnt(8)
    v_add3_u32 v20, v200, v201, s40
    v_add3_u32 v20, v20, v202, v203
    v_add3_u32 v20, v20, v204, v205
    v_add_u32 v20, v20, v206
    v_mfma_f32_32x32x16_bf16 v[224:239], v[104:107], v[196:199], v[224:239]
    v_cmp_ne_u32 vcc, v207, v20
    s_cbranch_vccnz S_ool_44
S_bk_45:
    v_mov_b32 v207, 0
    s_waitcnt lgkmcnt(0)
    v_mfma_f32_32x32x16_bf16 v[240:255], v[116:119], v[200:203], v[240:255]
    v_mfma_f32_32x32x16_bf16 v[224:239], v[112:115], v[200:203], v[224:239]
    s_waitcnt vmcnt(6)
    v_add3_u32 v20, v208, v209, s40
    v_add3_u32 v20, v20, v210, v211
    v_mfma_f32_32x32x16_bf16 v[240:255], v[124:127], v[204:207], v[240:255]
    s_add_u32 m0, s53, 49152
    s_add_u32 s95, s95, 57344
    s_cmp_eq_u32 s95, 1605632
    s_cselect_b32 s95, 0, s95
    buffer_load_dwordx4 v24, s[20:23], s95 offen lds
    buffer_load_dwordx4 v25, s[24:27], s95 offen offset:1024 lds
    ds_read_b64_tr_b16 a[0:1], v26
    ds_read_b64_tr_b16 a[2:3], v26 offset:512
    ds_read_b64_tr_b16 a[4:5], v27
    ds_read_b64_tr_b16 a[6:7], v27 offset:512
    v_mfma_f32_32x32x16_bf16 v[224:239], v[120:123], v[204:207], v[224:239]
    v_add3_u32 v20, v20, v212, v213
    v_add_u32 v20, v20, v214
    v_cmp_ne_u32 vcc, v215, v20
    s_cbranch_vccnz S_ool_49
S_bk_50:
    v_mov_b32 v215, 0
    v_mfma_f32_32x32x16_bf16 v[240:255], v[132:135], v[208:211], v[240:255]
    v_mfma_f32_32x32x16_bf16 v[224:239], v[128:131], v[208:211], v[224:239]
    s_waitcnt vmcnt(6)
    v_add3_u32 v20, v216, v217, s40
    v_add3_u32 v20, v20, v218, v219
    v_mfma_f32_32x32x16_bf16 v[240:255], v[140:143], v[212:215], v[240:255]
    v_add3_u32 v20, v20, v220, v221
    v_add_u32 v20, v20, v222
    v_cmp_ne_u32 vcc, v223, v20
    s_cbranch_vccnz S_ool_53
S_bk_54:
    v_mfma_f32_32x32x16_bf16 v[224:239], v[136:139], v[212:215], v[224:239]
    s_add_u32 m0, s53, 51200
    s_add_u32 s95, s95, 57344
    s_cmp_eq_u32 s95, 1605632
    s_cselect_b32 s95, 0, s95
    buffer_load_dwordx4 v24, s[20:23], s95 offen lds
    buffer_load_dwordx4 v25, s[24:27], s95 offen offset:1024 lds
    ds_read_b64_tr_b16 a[8:9], v26 offset:2048
    ds_read_b64_tr_b16 a[10:11], v26 offset:2560
    ds_read_b64_tr_b16 a[12:13], v27 offset:2048
    ds_read_b64_tr_b16 a[14:15], v27 offset:2560
    v_mov_b32 v223, 0
    v_mfma_f32_32x32x16_bf16 v[240:255], v[148:151], v[216:219], v[240:255]
    v_mfma_f32_32x32x16_bf16 v[224:239], v[144:147], v[216:219], v[224:239]
    v_mfma_f32_32x32x16_bf16 v[240:255], v[156:159], v[220:223], v[240:255]
    v_mfma_f32_32x32x16_bf16 v[224:239], v[152:155], v[220:223], v[224:239]
    s_waitcnt lgkmcnt(4)
    s_add_u32 m0, s53, 0
    s_add_u32 s95, s95, 57344
    s_cmp_eq_u32 s95, 1605632
    s_cselect_b32 s95, 0, s95
    buffer_load_dwordx4 v24, s[20:23], s95 offen lds
    buffer_load_dwordx4 v25, s[24:27], s95 offen offset:1024 lds
    ds_read_b64_tr_b16 a[16:17], v26 offset:16384
    ds_read_b64_tr_b16 a[18:19], v26 offset:16896
    ds_read_b64_tr_b16 a[20:21], v27 offset:16384
    ds_read_b64_tr_b16 a[22:23], v27 offset:16896
    ds_write_b128 v22, v[240:243]
    ds_write_b128 v22, v[244:247] offset:1024
    ds_write_b128 v22, v[248:251] offset:2048
    ds_write_b128 v22, v[252:255] offset:3072
    s_waitcnt lgkmcnt(0)
    s_barrier
    ds_read_b128 v[160:163], v23
    ds_read_b128 v[164:167], v23 offset:1024
    ds_read_b128 v[168:171], v23 offset:2048
    ds_read_b128 v[172:175], v23 offset:3072
    s_add_u32 m0, s53, 2048
    s_add_u32 s95, s95, 57344
    s_cmp_eq_u32 s95, 1605632
    s_cselect_b32 s95, 0, s95
    buffer_load_dwordx4 v24, s[20:23], s95 offen lds
    buffer_load_dwordx4 v25, s[24:27], s95 offen offset:1024 lds
    ds_read_b64_tr_b16 a[24:25], v26 offset:18432
    ds_read_b64_tr_b16 a[26:27], v26 offset:18944
    ds_read_b64_tr_b16 a[28:29], v27 offset:18432
    ds_read_b64_tr_b16 a[30:31], v27 offset:18944
    v_mov_b32 v184, 0
    v_mov_b32 v185, 0
    s_waitcnt lgkmcnt(6)
    v_pk_add_f32 v[224:225], v[224:225], v[160:161]
    v_pk_add_f32 v[226:227], v[226:227], v[162:163]
    v_pk_add_f32 v[228:229], v[228:229], v[164:165]
    v_pk_add_f32 v[230:231], v[230:231], v[166:167]
    v_cvt_pk_bf16_f32 v176, v224, v225
    v_cvt_pk_bf16_f32 v177, v226, v227
    v_cvt_pk_bf16_f32 v178, v228, v229
    v_cvt_pk_bf16_f32 v179, v230, v231
    buffer_store_dwordx4 v[176:179], v15, s[36:39], s62 offen sc1
    s_waitcnt lgkmcnt(4)
    v_pk_add_f32 v[232:233], v[232:233], v[168:169]
    v_pk_add_f32 v[234:235], v[234:235], v[170:171]
    v_pk_add_f32 v[236:237], v[236:237], v[172:173]
    v_pk_add_f32 v[238:239], v[238:239], v[174:175]
    v_cvt_pk_bf16_f32 v180, v232, v233
    v_cvt_pk_bf16_f32 v181, v234, v235
    v_cvt_pk_bf16_f32 v182, v236, v237
    v_cvt_pk_bf16_f32 v183, v238, v239
    buffer_store_dwordx4 v[180:183], v15, s[36:39], s62 offen offset:1024 sc1
    s_add_u32 m0, s53, 16384
    s_add_u32 s95, s95, 57344
    s_cmp_eq_u32 s95, 1605632
    s_cselect_b32 s95, 0, s95
    buffer_load_dwordx4 v24, s[20:23], s95 offen lds
    buffer_load_dwordx4 v25, s[24:27], s95 offen offset:1024 lds
    s_waitcnt vmcnt(14)
    ds_read_b64_tr_b16 a[32:33], v26 offset:32768
    ds_read_b64_tr_b16 a[34:35], v26 offset:33280
    ds_read_b64_tr_b16 a[36:37], v27 offset:32768
    ds_read_b64_tr_b16 a[38:39], v27 offset:33280
    v_dot2c_f32_bf16 v184, s54, v176
    v_dot2c_f32_bf16 v185, v176, v176
    v_dot2c_f32_bf16 v184, s54, v177
    v_dot2c_f32_bf16 v185, v177, v177
    v_dot2c_f32_bf16 v184, s54, v178
    v_dot2c_f32_bf16 v185, v178, v178
    v_dot2c_f32_bf16 v184, s54, v179
    v_dot2c_f32_bf16 v185, v179, v179
    v_dot2c_f32_bf16 v184, s54, v180
    v_dot2c_f32_bf16 v185, v180, v180
    v_dot2c_f32_bf16 v184, s54, v181
    v_dot2c_f32_bf16 v185, v181, v181
    v_dot2c_f32_bf16 v184, s54, v182
    s_waitcnt lgkmcnt(4)
    s_add_u32 m0, s53, 18432
    s_add_u32 s95, s95, 57344
    s_cmp_eq_u32 s95, 1605632
    s_cselect_b32 s95, 0, s95
    buffer_load_dwordx4 v24, s[20:23], s95 offen lds
    buffer_load_dwordx4 v25, s[24:27], s95 offen offset:1024 lds
    s_waitcnt vmcnt(14)
    ds_read_b64_tr_b16 a[40:41], v26 offset:34816
    ds_read_b64_tr_b16 a[42:43], v26 offset:35328
    ds_read_b64_tr_b16 a[44:45], v27 offset:34816
    ds_read_b64_tr_b16 a[46:47], v27 offset:35328
    v_dot2c_f32_bf16 v185, v182, v182
    v_dot2c_f32_bf16 v184, s54, v183
    v_dot2c_f32_bf16 v185, v183, v183
    s_nop 1
    v_mov_b32 v186, v184
    v_mov_b32 v187, v185
    s_nop 0
    v_permlane32_swap_b32 v184, v186
    v_permlane32_swap_b32 v185, v187
    v_pk_add_f32 v[184:185], v[184:185], v[186:187]
    s_xor_b32 s4, s2, 1
    s_or_b32 s4, s4, s3
    s_cbranch_scc1 L_ep_56
    s_mov_b32 s4, 688128
    v_mov_b32 v20, s40
    s_mov_b64 exec, 1
    buffer_store_dword v20, off, s[36:39], s4 sc1
    s_mov_b64 exec, -1
L_ep_56:
    v_add_u32 v7, 98304, v15
    v_add_u32 v8, s97, v7
    s_waitcnt lgkmcnt(4)
    s_add_u32 m0, s53, 32768
    s_add_u32 s95, s95, 57344
    s_cmp_eq_u32 s95, 1605632
    s_cselect_b32 s95, 0, s95
    buffer_load_dwordx4 v24, s[20:23], s95 offen lds
    buffer_load_dwordx4 v25, s[24:27], s95 offen offset:1024 lds
    s_waitcnt vmcnt(14)
    ds_read_b64_tr_b16 a[48:49], v26 offset:49152
    ds_read_b64_tr_b16 a[50:51], v26 offset:49664
    ds_read_b64_tr_b16 a[52:53], v27 offset:49152
    ds_read_b64_tr_b16 a[54:55], v27 offset:49664
    s_mul_i32 s4, s49, 114688
    s_add_u32 s4, s4, 3145728
    s_lshl_b32 s5, s51, 10
    s_add_u32 s5, s5, s97
    s_add_u32 s6, s5, 0
    s_sub_u32 s7, s6, 28672
    s_cselect_b32 s6, s6, s7
    s_add_u32 s65, s6, s4
    s_sub_u32 s4, s4, 1024
    s_add_u32 s6, s5, 1024
    s_sub_u32 s7, s6, 28672
    s_cselect_b32 s6, s6, s7
    s_add_u32 s66, s6, s4
    s_waitcnt lgkmcnt(4)
    s_add_u32 m0, s53, 34816
    s_add_u32 s95, s95, 57344
    s_cmp_eq_u32 s95, 1605632
    s_cselect_b32 s95, 0, s95
    buffer_load_dwordx4 v24, s[20:23], s95 offen lds
    buffer_load_dwordx4 v25, s[24:27], s95 offen offset:1024 lds
    s_waitcnt vmcnt(14)
    ds_read_b64_tr_b16 a[56:57], v26 offset:51200
    ds_read_b64_tr_b16 a[58:59], v26 offset:51712
    ds_read_b64_tr_b16 a[60:61], v27 offset:51200
    ds_read_b64_tr_b16 a[62:63], v27 offset:51712
    s_sub_u32 s4, s4, 1024
    s_add_u32 s6, s5, 2048
    s_sub_u32 s7, s6, 28672
    s_cselect_b32 s6, s6, s7
    s_add_u32 s67, s6, s4
    s_sub_u32 s4, s4, 1024
    s_add_u32 s6, s5, 3072
    s_sub_u32 s7, s6, 28672
    s_cselect_b32 s6, s6, s7
    s_add_u32 s68, s6, s4
    s_sub_u32 s4, s4, -3072
    s_add_u32 s6, s5, 4096
    s_sub_u32 s7, s6, 28672
    s_cselect_b32 s6, s6, s7
    s_waitcnt lgkmcnt(4)
    s_add_u32 m0, s53, 49152
    s_add_u32 s95, s95, 57344
    s_cmp_eq_u32 s95, 1605632
    s_cselect_b32 s95, 0, s95
    buffer_load_dwordx4 v24, s[20:23], s95 offen lds
    buffer_load_dwordx4 v25, s[24:27], s95 offen offset:1024 lds
    s_waitcnt vmcnt(14)
    ds_read_b64_tr_b16 a[64:65], v26
    ds_read_b64_tr_b16 a[66:67], v26 offset:512
    ds_read_b64_tr_b16 a[68:69], v27
    ds_read_b64_tr_b16 a[70:71], v27 offset:512
    s_add_u32 s69, s6, s4
    s_sub_u32 s4, s4, 1024
    s_add_u32 s6, s5, 5120
    s_sub_u32 s7, s6, 28672
    s_cselect_b32 s6, s6, s7
    s_add_u32 s70, s6, s4
    s_sub_u32 s4, s4, 1024
    s_add_u32 s6, s5, 6144
    s_sub_u32 s7, s6, 28672
    s_cselect_b32 s6, s6, s7
    s_add_u32 s71, s6, s4
    s_barrier
    s_waitcnt lgkmcnt(4)
    s_add_u32 m0, s53, 51200
    s_add_u32 s95, s95, 57344
    s_cmp_eq_u32 s95, 1605632
    s_cselect_b32 s95, 0, s95
    buffer_load_dwordx4 v24, s[20:23], s95 offen lds
    buffer_load_dwordx4 v25, s[24:27], s95 offen offset:1024 lds
    s_waitcnt vmcnt(14)
    ds_read_b64_tr_b16 a[72:73], v26 offset:2048
    ds_read_b64_tr_b16 a[74:75], v26 offset:2560
    ds_read_b64_tr_b16 a[76:77], v27 offset:2048
    ds_read_b64_tr_b16 a[78:79], v27 offset:2560
    s_lshl2_add_u32 s4, s49, s3
    s_mul_i32 s4, s4, 3584
    s_add_u32 s86, s4, 5242880
    v_and_b32 v22, 31, v1
    s_lshl_b32 s4, s3, 8
    s_add_u32 s4, s4, 159744
    v_lshl_add_u32 v9, v1, 2, s4
    v_bfe_u32 v236, v1, 4, 1
    v_mul_u32_u24 v236, 14336, v236
    v_lshrrev_b32 v10, 5, v1
    v_lshl_add_u32 v236, v10, 7, v236
    v_and_b32 v10, 15, v1
    s_waitcnt lgkmcnt(4)
    s_add_u32 m0, s53, 0
    s_add_u32 s95, s95, 57344
    s_cmp_eq_u32 s95, 1605632
    s_cselect_b32 s95, 0, s95
    buffer_load_dwordx4 v24, s[20:23], s95 offen lds
    buffer_load_dwordx4 v25, s[24:27], s95 offen offset:1024 lds
    s_waitcnt vmcnt(12)
    ds_read_b64_tr_b16 a[80:81], v26 offset:16384
    ds_read_b64_tr_b16 a[82:83], v26 offset:16896
    ds_read_b64_tr_b16 a[84:85], v27 offset:16384
    ds_read_b64_tr_b16 a[86:87], v27 offset:16896
    v_lshl_add_u32 v236, v10, 3, v236
    s_lshl2_add_u32 s4, s48, s3
    s_lshl_b32 s4, s4, 8
    s_add_u32 s60, s4, 720896
    s_add_u32 s61, s4, 749568
    v_lshlrev_b32 v22, 4, v22
    v_add_u32 v22, 161792, v22
    v_and_b32 v23, 15, v1
    v_lshrrev_b32 v10, 5, v1
    v_lshl_add_u32 v23, v23, 1, v10
    s_lshl_b32 s4, s3, 9
    s_add_u32 s4, s4, 161792
    v_lshl_add_u32 v23, v23, 4, s4
    s_waitcnt lgkmcnt(4)
    s_add_u32 m0, s53, 2048
    s_add_u32 s95, s95, 57344
    s_cmp_eq_u32 s95, 1605632
    s_cselect_b32 s95, 0, s95
    buffer_load_dwordx4 v24, s[20:23], s95 offen lds
    buffer_load_dwordx4 v25, s[24:27], s95 offen offset:1024 lds
    s_waitcnt vmcnt(12)
    ds_read_b64_tr_b16 a[88:89], v26 offset:18432
    ds_read_b64_tr_b16 a[90:91], v26 offset:18944
    ds_read_b64_tr_b16 a[92:93], v27 offset:18432
    ds_read_b64_tr_b16 a[94:95], v27 offset:18944
    v_bfe_u32 v14, v1, 2, 2
    s_lshl2_add_u32 s4, s47, 28
    s_sub_u32 s4, s4, s51
    v_add_u32 v14, s4, v14
    v_subrev_u32 v10, 28, v14
    v_min_u32 v14, v14, v10
    v_lshlrev_b32 v14, 10, v14
    v_and_b32 v10, 1, v1
    v_lshl_add_u32 v14, v10, 9, v14
    v_and_b32 v10, 0x30, v1
    v_add_u32 v14, v10, v14
    v_and_b32 v10, 2, v1
    s_waitcnt lgkmcnt(4)
    s_add_u32 m0, s53, 16384
    s_add_u32 s95, s95, 57344
    s_cmp_eq_u32 s95, 1605632
    s_cselect_b32 s95, 0, s95
    buffer_load_dwordx4 v24, s[20:23], s95 offen lds
    buffer_load_dwordx4 v25, s[24:27], s95 offen offset:1024 lds
    s_waitcnt vmcnt(12)
    ds_read_b64_tr_b16 a[96:97], v26 offset:32768
    ds_read_b64_tr_b16 a[98:99], v26 offset:33280
    ds_read_b64_tr_b16 a[100:101], v27 offset:32768
    ds_read_b64_tr_b16 a[102:103], v27 offset:33280
    v_lshl_add_u32 v14, v10, 2, v14
    s_add_u32 s4, s45, 384
    s_lshl2_add_u32 s4, s4, s3
    s_lshl_b32 s4, s4, 6
    v_add_u32 v14, s4, v14
    v_bfe_u32 v10, v1, 2, 3
    v_lshrrev_b32 v11, 5, v1
    v_lshl_add_u32 v10, v11, 4, v10
    v_lshlrev_b32 v10, 7, v10
    v_bfe_u32 v11, v1, 3, 2
    v_lshl_add_u32 v10, v11, 5, v10
    s_waitcnt lgkmcnt(4)
    s_add_u32 m0, s53, 18432
    s_add_u32 s95, s95, 57344
    s_cmp_eq_u32 s95, 1605632
    s_cselect_b32 s95, 0, s95
    buffer_load_dwordx4 v24, s[20:23], s95 offen lds
    buffer_load_dwordx4 v25, s[24:27], s95 offen offset:1024 lds
    s_waitcnt vmcnt(12)
    ds_read_b64_tr_b16 a[104:105], v26 offset:34816
    ds_read_b64_tr_b16 a[106:107], v26 offset:35328
    ds_read_b64_tr_b16 a[108:109], v27 offset:34816
    ds_read_b64_tr_b16 a[110:111], v27 offset:35328
    v_and_b32 v11, 3, v1
    v_lshl_add_u32 v10, v11, 3, v10
    s_add_u32 s4, s53, 32768
    v_add_u32 v10, s4, v10
    v_xor_b32 v11, 32, v10
    v_xor_b32 v12, 64, v10
    v_xor_b32 v13, 96, v10
    v_add_u32 v16, 0x10000, v10
    v_add_u32 v17, 0x10000, v11
    v_add_u32 v18, 0x10000, v12
    v_add_u32 v19, 0x10000, v13
    s_mov_b32 exec_hi, 0
    buffer_store_dwordx2 v[184:185], v6, s[36:39], s63 offen sc1
    s_mov_b64 exec, -1
    s_mul_i32 s92, s3, 401408
    s_lshl_b32 s4, s44, 4
    s_waitcnt lgkmcnt(4)
    s_add_u32 m0, s53, 32768
    s_add_u32 s95, s95, 57344
    s_cmp_eq_u32 s95, 1605632
    s_cselect_b32 s95, 0, s95
    buffer_load_dwordx4 v24, s[20:23], s95 offen lds
    buffer_load_dwordx4 v25, s[24:27], s95 offen offset:1024 lds
    s_waitcnt vmcnt(13)
    ds_read_b64_tr_b16 a[112:113], v26 offset:49152
    ds_read_b64_tr_b16 a[114:115], v26 offset:49664
    ds_read_b64_tr_b16 a[116:117], v27 offset:49152
    ds_read_b64_tr_b16 a[118:119], v27 offset:49664
    s_add_u32 s4, s4, s3
    s_mul_i32 s4, s4, 28672
    s_lshl_b32 s5, s45, 8
    s_add_u32 s4, s4, s5
    s_add_u32 s4, s4, 6291456
    s_add_u32 s79, s4, 0
    s_add_u32 s80, s4, 4096
    s_add_u32 s81, s4, 8192
    s_add_u32 s82, s4, 12288
    s_add_u32 s83, s4, 16384
    s_add_u32 s84, s4, 20480
    s_add_u32 s85, s4, 24576
    v_lshrrev_b32 v2, 3, v1
    s_waitcnt lgkmcnt(4)
    s_add_u32 m0, s53, 34816
    s_add_u32 s95, s95, 57344
    s_cmp_eq_u32 s95, 1605632
    s_cselect_b32 s95, 0, s95
    buffer_load_dwordx4 v24, s[20:23], s95 offen lds
    buffer_load_dwordx4 v25, s[24:27], s95 offen offset:1024 lds
    s_waitcnt vmcnt(13)
    ds_read_b64_tr_b16 a[120:121], v26 offset:51200
    ds_read_b64_tr_b16 a[122:123], v26 offset:51712
    ds_read_b64_tr_b16 a[124:125], v27 offset:51200
    ds_read_b64_tr_b16 a[126:127], v27 offset:51712
    v_mul_u32_u24 v2, 896, v2
    v_and_b32 v3, 0x70, v15
    v_lshrrev_b32 v4, 4, v1
    v_lshlrev_b32 v4, 5, v4
    v_xor_b32 v3, v3, v4
    s_lshl_b32 s4, s47, 7
    v_add3_u32 v2, v2, v3, s4
    v_add_u32 v3, 6144, v2
    v_add_u32 v4, 12288, v2
    v_add_u32 v5, 18432, v2
    v_add_u32 v28, 28672, v15
    v_add_u32 v29, 57344, v15
    s_add_u32 m0, s97, 98304
    s_nop 0
    buffer_load_dwordx4 v15, s[36:39], s65 offen sc1 lds
    buffer_load_dwordx4 v15, s[36:39], s66 offen offset:1024 sc1 lds
    buffer_load_dwordx4 v15, s[36:39], s67 offen offset:2048 sc1 lds
    buffer_load_dwordx4 v15, s[36:39], s68 offen offset:3072 sc1 lds
    s_add_u32 m0, s97, 102400
    s_nop 0
    buffer_load_dwordx4 v15, s[36:39], s69 offen sc1 lds
    buffer_load_dwordx4 v15, s[36:39], s70 offen offset:1024 sc1 lds
    buffer_load_dwordx4 v15, s[36:39], s71 offen offset:2048 sc1 lds
    s_add_u32 m0, s97, 131072
    s_nop 0
    buffer_load_dwordx4 v28, s[36:39], s65 offen sc1 lds
    buffer_load_dwordx4 v28, s[36:39], s66 offen offset:1024 sc1 lds
    buffer_load_dwordx4 v28, s[36:39], s67 offen offset:2048 sc1 lds
    buffer_load_dwordx4 v28, s[36:39], s68 offen offset:3072 sc1 lds
    s_add_u32 m0, s97, 135168
    s_nop 0
    buffer_load_dwordx4 v28, s[36:39], s69 offen sc1 lds
    buffer_load_dwordx4 v28, s[36:39], s70 offen offset:1024 sc1 lds
    s_waitcnt vmcnt(12)
    ds_read_b128 v[32:35], v8
    s_waitcnt vmcnt(11)
    ds_read_b128 v[36:39], v8 offset:1024
    buffer_load_dwordx4 v28, s[36:39], s71 offen offset:2048 sc1 lds
    s_waitcnt vmcnt(11)
    ds_read_b128 v[40:43], v8 offset:2048
    s_waitcnt lgkmcnt(2)
    v_max3_u32 v21, v32, v33, v34
    v_max3_u32 v21, v21, v35, v35
    s_add_u32 m0, s53, 49152
    s_add_u32 s95, s95, 57344
    s_cmp_eq_u32 s95, 1605632
    s_cselect_b32 s95, 0, s95
    buffer_load_dwordx4 v24, s[20:23], s95 offen lds
    buffer_load_dwordx4 v25, s[24:27], s95 offen offset:1024 lds
    ds_read_b64_tr_b16 a[128:129], v26
    ds_read_b64_tr_b16 a[130:131], v26 offset:512
    ds_read_b64_tr_b16 a[132:133], v27
    ds_read_b64_tr_b16 a[134:135], v27 offset:512
    s_waitcnt vmcnt(12)
    ds_read_b128 v[44:47], v8 offset:3072
    s_waitcnt lgkmcnt(6)
    v_max3_u32 v21, v21, v36, v37
    v_max3_u32 v21, v21, v38, v39
    s_waitcnt vmcnt(11)
    ds_read_b128 v[48:51], v8 offset:4096
    s_waitcnt lgkmcnt(6)
    v_max3_u32 v21, v21, v40, v41
    v_max3_u32 v21, v21, v42, v43
    s_add_u32 m0, s53, 51200
    s_add_u32 s95, s95, 57344
    s_cmp_eq_u32 s95, 1605632
    s_cselect_b32 s95, 0, s95
    buffer_load_dwordx4 v24, s[20:23], s95 offen lds
    buffer_load_dwordx4 v25, s[24:27], s95 offen offset:1024 lds
    ds_read_b64_tr_b16 a[136:137], v26 offset:2048
    ds_read_b64_tr_b16 a[138:139], v26 offset:2560
    ds_read_b64_tr_b16 a[140:141], v27 offset:2048
    ds_read_b64_tr_b16 a[142:143], v27 offset:2560
    s_waitcnt vmcnt(12)
    ds_read_b128 v[52:55], v8 offset:5120
    s_waitcnt lgkmcnt(6)
    v_max3_u32 v21, v21, v44, v45
    v_max3_u32 v21, v21, v46, v47
    s_waitcnt vmcnt(11)
    ds_read_b128 v[56:59], v8 offset:6144
    s_waitcnt lgkmcnt(6)
    v_max3_u32 v21, v21, v48, v49
    v_max3_u32 v21, v21, v50, v51
    s_waitcnt lgkmcnt(1)
    v_max3_u32 v21, v21, v52, v53
    v_max3_u32 v21, v21, v54, v55
    s_waitcnt lgkmcnt(0)
    v_max3_u32 v21, v21, v56, v57
    v_max3_u32 v21, v21, v58, v59
    v_cmp_eq_u32 vcc, -1, v21
    s_cbranch_vccnz L_hc_57
L_hb_58:
    s_barrier
    ds_read_b128 v[128:131], v7
    ds_read_b128 v[132:135], v7 offset:1024
    ds_read_b128 v[136:139], v7 offset:2048
    ds_read_b128 v[140:143], v7 offset:3072
    s_waitcnt lgkmcnt(3)
    v_mfma_f32_32x32x16_bf16 v[32:47], a[0:3], v[128:131], 0
    ds_read_b128 v[144:147], v7 offset:4096
    s_add_u32 m0, s53, 0
    s_add_u32 s95, s95, 57344
    s_cmp_eq_u32 s95, 1605632
    s_cselect_b32 s95, 0, s95
    buffer_load_dwordx4 v24, s[20:23], s95 offen lds
    v_mfma_f32_32x32x16_bf16 v[48:63], a[4:7], v[128:131], 0
    ds_read_b64_tr_b16 a[144:145], v26 offset:16384
    ds_read_b64_tr_b16 a[146:147], v26 offset:16896
    ds_read_b64_tr_b16 a[148:149], v27 offset:16384
    ds_read_b64_tr_b16 a[150:151], v27 offset:16896
    s_waitcnt lgkmcnt(6)
    v_mfma_f32_32x32x16_bf16 v[32:47], a[8:11], v[132:135], v[32:47]
    ds_read_b128 v[148:151], v7 offset:5120
    ds_read_b64_tr_b16 a[152:153], v26 offset:18432
    ds_read_b64_tr_b16 a[154:155], v26 offset:18944
    v_mfma_f32_32x32x16_bf16 v[48:63], a[12:15], v[132:135], v[48:63]
    buffer_load_dwordx4 v25, s[24:27], s95 offen offset:1024 lds
    ds_read_b64_tr_b16 a[156:157], v27 offset:18432
    ds_read_b64_tr_b16 a[158:159], v27 offset:18944
    v_mfma_f32_32x32x16_bf16 v[32:47], a[16:19], v[136:139], v[32:47]
    ds_read_b128 v[128:131], v7 offset:6144
    ds_read_b64_tr_b16 a[160:161], v26 offset:32768
    ds_read_b64_tr_b16 a[162:163], v26 offset:33280
    v_mfma_f32_32x32x16_bf16 v[48:63], a[20:23], v[136:139], v[48:63]
    buffer_load_dwordx4 v[240:243], v15, s[36:39], s86 offen sc1
    ds_read_b64_tr_b16 a[164:165], v27 offset:32768
    ds_read_b64_tr_b16 a[166:167], v27 offset:33280
    s_waitcnt lgkmcnt(14)
    v_mfma_f32_32x32x16_bf16 v[32:47], a[24:27], v[140:143], v[32:47]
    ds_read_b128 v[132:135], v7 offset:7168
    ds_read_b64_tr_b16 a[168:169], v26 offset:34816
    ds_read_b64_tr_b16 a[170:171], v26 offset:35328
    v_mfma_f32_32x32x16_bf16 v[48:63], a[28:31], v[140:143], v[48:63]
    buffer_load_dwordx4 v[244:247], v15, s[36:39], s86 offen offset:1024 sc1
    ds_read_b64_tr_b16 a[172:173], v27 offset:34816
    ds_read_b64_tr_b16 a[174:175], v27 offset:35328
    v_mfma_f32_32x32x16_bf16 v[32:47], a[32:35], v[144:147], v[32:47]
    ds_read_b128 v[136:139], v7 offset:8192
    v_mfma_f32_32x32x16_bf16 v[48:63], a[36:39], v[144:147], v[48:63]
    buffer_load_dwordx4 v[248:251], v15, s[36:39], s86 offen offset:2048 sc1
    s_waitcnt lgkmcnt(10)
    v_mfma_f32_32x32x16_bf16 v[32:47], a[40:43], v[148:151], v[32:47]
    ds_read_b128 v[140:143], v7 offset:9216
    s_waitcnt vmcnt(15)
    ds_read_b128 v[64:67], v8 offset:32768
    s_waitcnt vmcnt(14)
    v_mfma_f32_32x32x16_bf16 v[48:63], a[44:47], v[148:151], v[48:63]
    buffer_load_dwordx4 v[252:255], v15, s[36:39], s86 offen offset:2560 sc1
    ds_read_b128 v[68:71], v8 offset:33792
    s_waitcnt vmcnt(14)
    v_mfma_f32_32x32x16_bf16 v[32:47], a[48:51], v[128:131], v[32:47]
    ds_read_b128 v[144:147], v7 offset:10240
    ds_read_b128 v[72:75], v8 offset:34816
    v_mfma_f32_32x32x16_bf16 v[48:63], a[52:55], v[128:131], v[48:63]
    buffer_load_dwordx2 v[232:233], v236, s[36:39], s60 offen sc1
    s_waitcnt lgkmcnt(5)
    v_mfma_f32_32x32x16_bf16 v[32:47], a[56:59], v[132:135], v[32:47]
    ds_read_b128 v[148:151], v7 offset:11264
    v_mfma_f32_32x32x16_bf16 v[48:63], a[60:63], v[132:135], v[48:63]
    buffer_load_dwordx2 v[234:235], v236, s[36:39], s61 offen sc1
    s_waitcnt lgkmcnt(4)
    v_max3_u32 v160, v64, v65, v66
    v_max3_u32 v160, v160, v67, v67
    s_waitcnt vmcnt(15)
    v_mfma_f32_32x32x16_bf16 v[32:47], a[64:67], v[136:139], v[32:47]
    ds_read_b128 v[128:131], v7 offset:12288
    s_waitcnt vmcnt(10)
    ds_read_b64_tr_b16 a[176:177], v26 offset:49152
    ds_read_b128 v[76:79], v8 offset:35840
    s_waitcnt lgkmcnt(6)
    v_max3_u32 v160, v160, v68, v69
    v_mfma_f32_32x32x16_bf16 v[48:63], a[68:71], v[136:139], v[48:63]
    s_add_u32 m0, s53, 2048
    s_add_u32 s95, s95, 57344
    s_cmp_eq_u32 s95, 1605632
    s_cselect_b32 s95, 0, s95
    buffer_load_dwordx4 v24, s[20:23], s95 offen lds
    s_waitcnt lgkmcnt(5)
    v_mfma_f32_32x32x16_bf16 v[32:47], a[72:75], v[140:143], v[32:47]
    ds_read_b128 v[132:135], v7 offset:13312
    ds_read_b64_tr_b16 a[178:179], v26 offset:49664
    ds_read_b64_tr_b16 a[180:181], v27 offset:49152
    v_max3_u32 v160, v160, v70, v71
    v_mfma_f32_32x32x16_bf16 v[48:63], a[76:79], v[140:143], v[48:63]
    ds_read_b64_tr_b16 a[182:183], v27 offset:49664
    ds_read_b128 v[80:83], v8 offset:36864
    s_waitcnt lgkmcnt(9)
    v_max3_u32 v160, v160, v72, v73
    v_max3_u32 v160, v160, v74, v75
    v_mfma_f32_32x32x16_bf16 v[32:47], a[80:83], v[144:147], v[32:47]
    ds_read_b128 v[136:139], v7 offset:14336
    buffer_load_dwordx4 v25, s[24:27], s95 offen offset:1024 lds
    s_waitcnt vmcnt(10)
    ds_read_b64_tr_b16 a[184:185], v26 offset:51200
    ds_read_b128 v[84:87], v8 offset:37888
    v_mfma_f32_32x32x16_bf16 v[48:63], a[84:87], v[144:147], v[48:63]
    ds_read_b64_tr_b16 a[186:187], v26 offset:51712
    s_waitcnt lgkmcnt(9)
    v_max3_u32 v160, v160, v76, v77
    v_max3_u32 v160, v160, v78, v79
    v_mfma_f32_32x32x16_bf16 v[32:47], a[88:91], v[148:151], v[32:47]
    ds_read_b128 v[140:143], v7 offset:15360
    s_add_u32 m0, s53, 16384
    s_add_u32 s95, s95, 57344
    s_cmp_eq_u32 s95, 1605632
    s_cselect_b32 s95, 0, s95
    buffer_load_dwordx4 v24, s[20:23], s95 offen lds
    v_mfma_f32_32x32x16_bf16 v[48:63], a[92:95], v[148:151], v[48:63]
    ds_read_b64_tr_b16 a[188:189], v27 offset:51200
    ds_read_b64_tr_b16 a[190:191], v27 offset:51712
    ds_read_b128 v[88:91], v8 offset:38912
    v_mfma_f32_32x32x16_bf16 v[32:47], a[96:99], v[128:131], v[32:47]
    ds_read_b128 v[144:147], v7 offset:16384
    s_waitcnt lgkmcnt(9)
    v_max3_u32 v160, v160, v80, v81
    v_max3_u32 v160, v160, v82, v83
    v_mfma_f32_32x32x16_bf16 v[48:63], a[100:103], v[128:131], v[48:63]
    buffer_load_dwordx4 v25, s[24:27], s95 offen offset:1024 lds
    s_waitcnt lgkmcnt(8)
    v_mfma_f32_32x32x16_bf16 v[32:47], a[104:107], v[132:135], v[32:47]
    ds_read_b128 v[148:151], v7 offset:17408
    s_waitcnt lgkmcnt(7)
    v_max3_u32 v160, v160, v84, v85
    v_max3_u32 v160, v160, v86, v87
    v_mfma_f32_32x32x16_bf16 v[48:63], a[108:111], v[132:135], v[48:63]
    s_add_u32 m0, s53, 18432
    s_add_u32 s95, s95, 57344
    s_cmp_eq_u32 s95, 1605632
    s_cselect_b32 s95, 0, s95
    buffer_load_dwordx4 v24, s[20:23], s95 offen lds
    v_mfma_f32_32x32x16_bf16 v[32:47], a[112:115], v[136:139], v[32:47]
    ds_read_b128 v[128:131], v7 offset:18432
    s_waitcnt lgkmcnt(3)
    v_max3_u32 v160, v160, v88, v89
    v_max3_u32 v160, v160, v90, v91
    v_mfma_f32_32x32x16_bf16 v[48:63], a[116:119], v[136:139], v[48:63]
    v_cmp_eq_u32 vcc, -1, v160
    s_cbranch_vccnz L_hc_78
L_hb_79:
    s_waitcnt lgkmcnt(2)
    v_mfma_f32_32x32x16_bf16 v[32:47], a[120:123], v[140:143], v[32:47]
    ds_read_b128 v[132:135], v7 offset:19456
    buffer_load_dwordx4 v25, s[24:27], s95 offen offset:1024 lds
    ds_read_b64 v[168:169], v14
    v_mfma_f32_32x32x16_bf16 v[48:63], a[124:127], v[140:143], v[48:63]
    v_mfma_f32_32x32x16_bf16 v[32:47], a[128:131], v[144:147], v[32:47]
    ds_read_b128 v[136:139], v7 offset:20480
    s_add_u32 m0, s53, 65536
    s_add_u32 s88, s92, 0
    buffer_load_dwordx4 v2, s[28:31], s88 offen lds
    v_mfma_f32_32x32x16_bf16 v[48:63], a[132:135], v[144:147], v[48:63]
    s_waitcnt lgkmcnt(3)
    v_mfma_f32_32x32x16_bf16 v[32:47], a[136:139], v[148:151], v[32:47]
    ds_read_b128 v[140:143], v7 offset:21504
    s_waitcnt vmcnt(9)
    v_max3_u32 v20, v240, v241, v242
    v_max3_u32 v20, v20, v243, v244
    v_max3_u32 v20, v20, v245, v246
    v_mfma_f32_32x32x16_bf16 v[48:63], a[140:143], v[148:151], v[48:63]
    buffer_load_dwordx4 v3, s[28:31], s88 offen offset:1024 lds
    v_max3_u32 v20, v20, v247, v248
    v_max3_u32 v20, v20, v249, v250
    v_max3_u32 v20, v20, v251, v252
    v_mfma_f32_32x32x16_bf16 v[32:47], a[144:147], v[128:131], v[32:47]
    ds_read_b128 v[144:147], v7 offset:22528
    v_max3_u32 v20, v20, v253, v254
    v_max3_u32 v20, v20, v255, v255
    v_mfma_f32_32x32x16_bf16 v[48:63], a[148:151], v[128:131], v[48:63]
    buffer_load_dwordx4 v4, s[28:31], s88 offen offset:2048 lds
    v_cmp_eq_u32 vcc, -1, v20
    s_cbranch_vccnz L_chk_68
L_bk_69:
    s_waitcnt lgkmcnt(2)
    v_mfma_f32_32x32x16_bf16 v[32:47], a[152:155], v[132:135], v[32:47]
    ds_read_b128 v[148:151], v7 offset:23552
    v_cndmask_b32 v252, 0, v252, s[0:1]
    v_cndmask_b32 v253, 0, v253, s[0:1]
    v_cndmask_b32 v254, 0, v254, s[0:1]
    v_cndmask_b32 v255, 0, v255, s[0:1]
    v_add_f32 v240, v240, v248
    v_mfma_f32_32x32x16_bf16 v[48:63], a[156:159], v[132:135], v[48:63]
    s_waitcnt vmcnt(9)
    ds_read_b64_tr_b16 a[192:193], v26
    v_add_f32 v241, v241, v249
    v_add_f32 v242, v242, v250
    v_add_f32 v243, v243, v251
    v_mfma_f32_32x32x16_bf16 v[32:47], a[160:163], v[136:139], v[32:47]
    ds_read_b128 v[128:131], v7 offset:24576
    buffer_load_dwordx4 v5, s[28:31], s88 offen offset:3072 lds
    ds_read_b64_tr_b16 a[194:195], v26 offset:512
    v_add_f32 v244, v244, v252
    v_add_f32 v245, v245, v253
    v_add_f32 v246, v246, v254
    v_mfma_f32_32x32x16_bf16 v[48:63], a[164:167], v[136:139], v[48:63]
    ds_read_b64_tr_b16 a[196:197], v27
    s_waitcnt vmcnt(8)
    ds_read_b64_tr_b16 a[200:201], v26 offset:2048
    v_add_f32 v247, v247, v255
    v_add_f32 v240, v240, v244
    v_bitop3_b32 v233, s40, v232, v233 bitop3:0x96
    v_bitop3_b32 v235, s40, v234, v235 bitop3:0x96
    v_or_b32 v233, v233, v235
    v_cmp_ne_u32 vcc, 0, v233
    s_cbranch_vccnz L_tg_66
L_tb_67:
    v_add_f32 v232, v232, v234
    ds_write_b32 v9, v232
    s_waitcnt lgkmcnt(7)
    v_mfma_f32_32x32x16_bf16 v[32:47], a[168:171], v[140:143], v[32:47]
    ds_read_b128 v[132:135], v7 offset:25600
    s_add_u32 m0, s53, 81920
    s_add_u32 s88, s92, 28672
    buffer_load_dwordx4 v2, s[28:31], s88 offen lds
    ds_read_b64_tr_b16 a[198:199], v27 offset:512
    ds_read_b64_tr_b16 a[202:203], v26 offset:2560
    v_add_f32 v241, v241, v245
    v_add_f32 v242, v242, v246
    v_add_f32 v243, v243, v247
    s_nop 0
    v_permlane32_swap_b32 v240, v242
    v_mfma_f32_32x32x16_bf16 v[48:63], a[172:175], v[140:143], v[48:63]
    ds_read_b128 v[96:99], v30
    ds_read_b64_tr_b16 a[204:205], v27 offset:2048
    s_waitcnt vmcnt(7)
    ds_read_b64_tr_b16 a[208:209], v26 offset:16384
    v_permlane32_swap_b32 v241, v243
    v_add_f32 v240, v240, v242
    v_add_f32 v241, v241, v243
    v_mfma_f32_32x32x16_bf16 v[32:47], a[176:179], v[144:147], v[32:47]
    ds_read_b128 v[136:139], v7 offset:26624
    buffer_load_dwordx4 v3, s[28:31], s88 offen offset:1024 lds
    ds_read_b128 v[100:103], v30 offset:32
    ds_read_b64_tr_b16 a[206:207], v27 offset:2560
    ds_read_b64_tr_b16 a[210:211], v26 offset:16896
    v_mov_b32 v242, v240
    v_mov_b32 v243, v241
    s_nop 0
    v_permlane16_swap_b32 v240, v242
    v_permlane16_swap_b32 v241, v243
    v_mfma_f32_32x32x16_bf16 v[48:63], a[180:183], v[144:147], v[48:63]
    ds_read_b64_tr_b16 a[212:213], v27 offset:16384
    s_waitcnt vmcnt(6)
    ds_read_b64_tr_b16 a[216:217], v26 offset:18432
    v_add_f32 v240, v240, v242
    v_add_f32 v241, v241, v243
    v_mul_f32 v244, 0xbb124925, v240
    v_mul_f32 v247, 0x3b124925, v241
    s_waitcnt lgkmcnt(15)
    v_mfma_f32_32x32x16_bf16 v[32:47], a[184:187], v[148:151], v[32:47]
    ds_read_b128 v[140:143], v7 offset:27648
    buffer_load_dwordx4 v4, s[28:31], s88 offen offset:2048 lds
    ds_read_b128 v[104:107], v30 offset:64
    ds_read_b64_tr_b16 a[214:215], v27 offset:16896
    ds_read_b64_tr_b16 a[218:219], v26 offset:18944
    v_fma_f32 v247, -v244, v244, v247
    v_max_f32 v247, 0, v247
    v_add_f32 v247, 0x3727c5ac, v247
    v_mfma_f32_32x32x16_bf16 v[48:63], a[188:191], v[148:151], v[48:63]
    ds_read_b64_tr_b16 a[220:221], v27 offset:18432
    v_rsq_f32 v245, v247
    s_nop 0
    v_mul_f32 v246, v245, v245
    v_mul_f32 v246, v246, v245
    v_mul_f32 v246, 0xbdd2d3e8, v246
    v_mul_f32 v245, 0xc0135761, v245
    ds_write_b128 v23, v[244:247]
    s_waitcnt lgkmcnt(15)
    v_mfma_f32_32x32x16_bf16 v[32:47], a[192:195], v[128:131], v[32:47]
    buffer_load_dwordx4 v5, s[28:31], s88 offen offset:3072 lds
    ds_read_b128 v[108:111], v30 offset:96
    ds_read_b64_tr_b16 a[222:223], v27 offset:18944
    v_mfma_f32_32x32x16_bf16 v[48:63], a[196:199], v[128:131], v[48:63]
    s_waitcnt lgkmcnt(0)
    s_barrier
    v_add_u32 v28, 86016, v15
    v_mfma_f32_32x32x16_bf16 v[32:47], a[200:203], v[132:135], v[32:47]
    ds_read_b128 v[144:147], v7 offset:32768
    ds_read_b128 v[148:151], v7 offset:33792
    s_add_u32 m0, s97, 32768
    s_nop 0
    buffer_load_dwordx4 v29, s[36:39], s65 offen sc1 lds
    ds_read_b128 v[112:115], v30 offset:128
    v_mfma_f32_32x32x16_bf16 v[48:63], a[204:207], v[132:135], v[48:63]
    ds_read_b128 v[116:119], v30 offset:160
    ds_read_b128 v[152:155], v22 offset:0
    v_mfma_f32_32x32x16_bf16 v[32:47], a[208:211], v[136:139], v[32:47]
    ds_read_b128 v[128:131], v7 offset:34816
    buffer_load_dwordx4 v29, s[36:39], s66 offen offset:1024 sc1 lds
    v_mfma_f32_32x32x16_bf16 v[48:63], a[212:215], v[136:139], v[48:63]
    ds_read_b128 v[120:123], v30 offset:192
    ds_read_b64 v[170:171], v14 offset:32768
    s_waitcnt lgkmcnt(7)
    v_mfma_f32_32x32x16_bf16 v[32:47], a[216:219], v[140:143], v[32:47]
    ds_read_b128 v[132:135], v7 offset:35840
    buffer_load_dwordx4 v29, s[36:39], s67 offen offset:2048 sc1 lds
    v_subrev_u32 v14, 98304, v14
    v_mfma_f32_32x32x16_bf16 v[48:63], a[220:223], v[140:143], v[48:63]
    ds_read_b128 v[124:127], v30 offset:224
    v_mfma_f32_32x32x16_bf16 v[64:79], a[0:3], v[144:147], 0
    ds_read_b128 v[136:139], v7 offset:36864
    buffer_load_dwordx4 v29, s[36:39], s68 offen offset:3072 sc1 lds
    v_mfma_f32_32x32x16_bf16 v[80:95], a[4:7], v[144:147], 0
    s_waitcnt lgkmcnt(5)
    v_mfma_f32_32x32x16_bf16 v[64:79], a[8:11], v[148:151], v[64:79]
    ds_read_b128 v[140:143], v7 offset:37888
    s_add_u32 m0, s97, 36864
    s_nop 0
    buffer_load_dwordx4 v29, s[36:39], s69 offen sc1 lds
    v_mfma_f32_32x32x16_bf16 v[80:95], a[12:15], v[148:151], v[80:95]
    v_mfma_f32_32x32x16_bf16 v[64:79], a[16:19], v[128:131], v[64:79]
    ds_read_b128 v[144:147], v7 offset:38912
    buffer_load_dwordx4 v29, s[36:39], s70 offen offset:1024 sc1 lds
    s_waitcnt lgkmcnt(3)
    s_add_u32 s7, s91, 0
    v_fmac_f32 v32, v152, v96
    v_fmac_f32 v33, v152, v97
    v_fmac_f32 v34, v152, v98
    v_fmac_f32 v35, v152, v99
    v_mfma_f32_32x32x16_bf16 v[80:95], a[20:23], v[128:131], v[80:95]
    v_mul_f32 v160, v32, v32
    v_mul_f32 v161, v33, v33
    v_mul_f32 v162, v34, v34
    v_mul_f32 v163, v35, v35
    v_fma_f32 v160, v160, v154, v153
    s_waitcnt lgkmcnt(2)
    v_mfma_f32_32x32x16_bf16 v[64:79], a[24:27], v[132:135], v[64:79]
    ds_read_b128 v[148:151], v7 offset:39936
    buffer_load_dwordx4 v29, s[36:39], s71 offen offset:2048 sc1 lds
    v_fma_f32 v161, v161, v154, v153
    v_fma_f32 v162, v162, v154, v153
    v_fma_f32 v163, v163, v154, v153
    v_mfma_f32_32x32x16_bf16 v[80:95], a[28:31], v[132:135], v[80:95]
    v_mul_f32 v160, v160, v32
    v_mul_f32 v161, v161, v33
    v_mul_f32 v162, v162, v34
    v_mul_f32 v163, v163, v35
    v_exp_f32 v160, v160
    v_mfma_f32_32x32x16_bf16 v[64:79], a[32:35], v[136:139], v[64:79]
    ds_read_b128 v[128:131], v7 offset:40960
    s_add_u32 m0, s53, 98304
    s_add_u32 s88, s92, 57344
    buffer_load_dwordx4 v2, s[28:31], s88 offen lds
    v_fmac_f32 v40, v152, v104
    v_mfma_f32_32x32x16_bf16 v[80:95], a[36:39], v[136:139], v[80:95]
    v_exp_f32 v161, v161
    v_fmac_f32 v41, v152, v105
    v_exp_f32 v162, v162
    s_waitcnt lgkmcnt(2)
    v_mfma_f32_32x32x16_bf16 v[64:79], a[40:43], v[140:143], v[64:79]
    ds_read_b128 v[132:135], v7 offset:41984
    v_fmac_f32 v42, v152, v106
    v_exp_f32 v163, v163
    v_fmac_f32 v43, v152, v107
    v_fma_f32 v160, v160, v155, v155
    v_mfma_f32_32x32x16_bf16 v[80:95], a[44:47], v[140:143], v[80:95]
    buffer_load_dwordx4 v3, s[28:31], s88 offen offset:1024 lds
    v_fma_f32 v161, v161, v155, v155
    v_fma_f32 v162, v162, v155, v155
    v_fma_f32 v163, v163, v155, v155
    v_mfma_f32_32x32x16_bf16 v[64:79], a[48:51], v[144:147], v[64:79]
    ds_read_b128 v[136:139], v7 offset:43008
    v_rcp_f32 v160, v160
    v_mul_f32 v40, v40, v32
    v_rcp_f32 v161, v161
    v_mfma_f32_32x32x16_bf16 v[80:95], a[52:55], v[144:147], v[80:95]
    buffer_load_dwordx4 v4, s[28:31], s88 offen offset:2048 lds
    v_mul_f32 v41, v41, v33
    v_rcp_f32 v162, v162
    v_mul_f32 v42, v42, v34
    s_waitcnt lgkmcnt(2)
    v_mfma_f32_32x32x16_bf16 v[64:79], a[56:59], v[148:151], v[64:79]
    ds_read_b128 v[140:143], v7 offset:44032
    s_waitcnt vmcnt(14)
    ds_read_b64_tr_b16 a[224:225], v10 offset:32768
    v_rcp_f32 v163, v163
    v_mul_f32 v43, v43, v35
    v_mfma_f32_32x32x16_bf16 v[80:95], a[60:63], v[148:151], v[80:95]
    ds_read_b64_tr_b16 a[226:227], v10 offset:33792
    ds_read_b64_tr_b16 a[228:229], v11 offset:32768
    v_mul_f32 v40, v40, v160
    v_mul_f32 v41, v41, v161
    v_mul_f32 v42, v42, v162
    v_mul_f32 v43, v43, v163
    v_mfma_f32_32x32x16_bf16 v[64:79], a[64:67], v[128:131], v[64:79]
    ds_read_b128 v[144:147], v7 offset:45056
    buffer_load_dwordx4 v5, s[28:31], s88 offen offset:3072 lds
    ds_read_b64_tr_b16 a[230:231], v11 offset:33792
    v_cvt_pk_bf16_f32 v32, v40, v41
    v_cvt_pk_bf16_f32 v33, v42, v43
    v_mfma_f32_32x32x16_bf16 v[80:95], a[68:71], v[128:131], v[80:95]
    ds_read_b64_tr_b16 a[232:233], v12 offset:32768
    ds_read_b64_tr_b16 a[234:235], v12 offset:33792
    v_fmac_f32 v36, v152, v100
    v_fmac_f32 v37, v152, v101
    v_fmac_f32 v38, v152, v102
    v_fmac_f32 v39, v152, v103
    s_waitcnt lgkmcnt(8)
    v_mfma_f32_32x32x16_bf16 v[64:79], a[72:75], v[132:135], v[64:79]
    ds_read_b128 v[148:151], v7 offset:46080
    s_add_u32 m0, s53, 114688
    s_add_u32 s88, s92, 86016
    buffer_load_dwordx4 v2, s[28:31], s88 offen lds
    ds_read_b64_tr_b16 a[236:237], v13 offset:32768
    v_mul_f32 v164, v36, v36
    v_mul_f32 v165, v37, v37
    v_mul_f32 v166, v38, v38
    v_mul_f32 v167, v39, v39
    v_mfma_f32_32x32x16_bf16 v[80:95], a[76:79], v[132:135], v[80:95]
    ds_read_b64_tr_b16 a[238:239], v13 offset:33792
    s_waitcnt vmcnt(12)
    v_fma_f32 v164, v164, v154, v153
    v_fma_f32 v165, v165, v154, v153
    v_fma_f32 v166, v166, v154, v153
    v_mfma_f32_32x32x16_bf16 v[64:79], a[80:83], v[136:139], v[64:79]
    ds_read_b128 v[128:131], v7 offset:47104
    buffer_load_dwordx4 v3, s[28:31], s88 offen offset:1024 lds
    ds_read_b64_tr_b16 a[240:241], v10 offset:49152
    ds_read_b64_tr_b16 a[242:243], v10 offset:50176
    v_fma_f32 v167, v167, v154, v153
    v_mul_f32 v164, v164, v36
    v_mul_f32 v165, v165, v37
    v_mul_f32 v166, v166, v38
    v_mfma_f32_32x32x16_bf16 v[80:95], a[84:87], v[136:139], v[80:95]
    ds_read_b64_tr_b16 a[244:245], v11 offset:49152
    v_mul_f32 v167, v167, v39
    v_exp_f32 v164, v164
    v_fmac_f32 v44, v152, v108
    s_waitcnt lgkmcnt(10)
    v_mfma_f32_32x32x16_bf16 v[64:79], a[88:91], v[140:143], v[64:79]
    ds_read_b128 v[132:135], v7 offset:48128
    buffer_load_dwordx4 v4, s[28:31], s88 offen offset:2048 lds
    ds_read_b64_tr_b16 a[246:247], v11 offset:50176
    ds_read_b64_tr_b16 a[248:249], v12 offset:49152
    v_exp_f32 v165, v165
    v_fmac_f32 v45, v152, v109
    v_exp_f32 v166, v166
    v_mfma_f32_32x32x16_bf16 v[80:95], a[92:95], v[140:143], v[80:95]
    ds_read_b64_tr_b16 a[250:251], v12 offset:50176
    v_fmac_f32 v46, v152, v110
    v_exp_f32 v167, v167
    v_fmac_f32 v47, v152, v111
    v_fma_f32 v164, v164, v155, v155
    v_mfma_f32_32x32x16_bf16 v[64:79], a[96:99], v[144:147], v[64:79]
    ds_read_b128 v[136:139], v7 offset:49152
    buffer_load_dwordx4 v5, s[28:31], s88 offen offset:3072 lds
    ds_read_b64_tr_b16 a[252:253], v13 offset:49152
    ds_read_b64_tr_b16 a[254:255], v13 offset:50176
    v_fma_f32 v165, v165, v155, v155
    v_fma_f32 v166, v166, v155, v155
    v_mfma_f32_32x32x16_bf16 v[80:95], a[100:103], v[144:147], v[80:95]
    s_waitcnt lgkmcnt(0)
    v_fma_f32 v167, v167, v155, v155
    v_rcp_f32 v164, v164
    v_mul_f32 v44, v44, v36
    v_mfma_f32_32x32x16_bf16 v[64:79], a[104:107], v[148:151], v[64:79]
    ds_read_b128 v[140:143], v7 offset:50176
    s_add_u32 m0, s53, 65536
    s_add_u32 s88, s92, 114688
    buffer_load_dwordx4 v2, s[28:31], s88 offen lds
    v_rcp_f32 v165, v165
    v_mul_f32 v45, v45, v37
    v_mfma_f32_32x32x16_bf16 v[80:95], a[108:111], v[148:151], v[80:95]
    v_rcp_f32 v166, v166
    v_mul_f32 v46, v46, v38
    v_rcp_f32 v167, v167
    v_mul_f32 v47, v47, v39
    v_mfma_f32_32x32x16_bf16 v[64:79], a[112:115], v[128:131], v[64:79]
    ds_read_b128 v[144:147], v7 offset:51200
    buffer_load_dwordx4 v3, s[28:31], s88 offen offset:1024 lds
    v_mul_f32 v44, v44, v164
    v_mul_f32 v45, v45, v165
    v_mul_f32 v46, v46, v166
    v_mul_f32 v47, v47, v167
    v_mfma_f32_32x32x16_bf16 v[80:95], a[116:119], v[128:131], v[80:95]
    v_cvt_pk_bf16_f32 v34, v44, v45
    v_cvt_pk_bf16_f32 v35, v46, v47
    v_mfma_f32_32x32x16_bf16 v[64:79], a[120:123], v[132:135], v[64:79]
    ds_read_b128 v[148:151], v7 offset:52224
    buffer_store_dwordx4 v[32:35], v15, s[36:39], s7 offen sc1
    v_fmac_f32 v48, v152, v112
    v_fmac_f32 v49, v152, v113
    v_fmac_f32 v50, v152, v114
    v_fmac_f32 v51, v152, v115
    v_mfma_f32_32x32x16_bf16 v[80:95], a[124:127], v[132:135], v[80:95]
    buffer_load_dwordx4 v4, s[28:31], s88 offen offset:2048 lds
    v_mul_f32 v160, v48, v48
    v_mul_f32 v161, v49, v49
    v_mul_f32 v162, v50, v50
    v_mul_f32 v163, v51, v51
    v_fma_f32 v160, v160, v154, v153
    v_mfma_f32_32x32x16_bf16 v[64:79], a[128:131], v[136:139], v[64:79]
    ds_read_b128 v[128:131], v7 offset:53248
    v_fma_f32 v161, v161, v154, v153
    v_fma_f32 v162, v162, v154, v153
    v_fma_f32 v163, v163, v154, v153
    v_mul_f32 v160, v160, v48
    v_mfma_f32_32x32x16_bf16 v[80:95], a[132:135], v[136:139], v[80:95]
    buffer_load_dwordx4 v5, s[28:31], s88 offen offset:3072 lds
    v_mul_f32 v161, v161, v49
    v_mul_f32 v162, v162, v50
    v_mul_f32 v163, v163, v51
    s_waitcnt lgkmcnt(2)
    v_mfma_f32_32x32x16_bf16 v[64:79], a[136:139], v[140:143], v[64:79]
    ds_read_b128 v[132:135], v7 offset:54272
    v_exp_f32 v160, v160
    v_fmac_f32 v56, v152, v120
    v_exp_f32 v161, v161
    v_mfma_f32_32x32x16_bf16 v[80:95], a[140:143], v[140:143], v[80:95]
    v_fmac_f32 v57, v152, v121
    v_exp_f32 v162, v162
    v_fmac_f32 v58, v152, v122
    v_exp_f32 v163, v163
    v_mfma_f32_32x32x16_bf16 v[64:79], a[144:147], v[144:147], v[64:79]
    ds_read_b128 v[136:139], v7 offset:55296
    s_add_u32 m0, s53, 81920
    s_add_u32 s88, s92, 143360
    buffer_load_dwordx4 v2, s[28:31], s88 offen lds
    v_fmac_f32 v59, v152, v123
    v_fma_f32 v160, v160, v155, v155
    v_mfma_f32_32x32x16_bf16 v[80:95], a[148:151], v[144:147], v[80:95]
    v_fma_f32 v161, v161, v155, v155
    v_fma_f32 v162, v162, v155, v155
    v_fma_f32 v163, v163, v155, v155
    s_waitcnt lgkmcnt(2)
    v_mfma_f32_32x32x16_bf16 v[64:79], a[152:155], v[148:151], v[64:79]
    ds_read_b128 v[140:143], v7 offset:56320
    v_rcp_f32 v160, v160
    v_mul_f32 v56, v56, v48
    v_rcp_f32 v161, v161
    v_mfma_f32_32x32x16_bf16 v[80:95], a[156:159], v[148:151], v[80:95]
    buffer_load_dwordx4 v3, s[28:31], s88 offen offset:1024 lds
    v_mul_f32 v57, v57, v49
    v_rcp_f32 v162, v162
    v_mul_f32 v58, v58, v50
    v_mfma_f32_32x32x16_bf16 v[64:79], a[160:163], v[128:131], v[64:79]
    ds_read_b128 v[144:147], v7 offset:57344
    v_rcp_f32 v163, v163
    v_mul_f32 v59, v59, v51
    v_mul_f32 v56, v56, v160
    v_mul_f32 v57, v57, v161
    v_mfma_f32_32x32x16_bf16 v[80:95], a[164:167], v[128:131], v[80:95]
    buffer_load_dwordx4 v4, s[28:31], s88 offen offset:2048 lds
    v_mul_f32 v58, v58, v162
    v_mul_f32 v59, v59, v163
    v_cvt_pk_bf16_f32 v48, v56, v57
    s_waitcnt lgkmcnt(2)
    v_mfma_f32_32x32x16_bf16 v[64:79], a[168:171], v[132:135], v[64:79]
    ds_read_b128 v[148:151], v7 offset:58368
    v_cvt_pk_bf16_f32 v49, v58, v59
    v_fmac_f32 v52, v152, v116
    v_fmac_f32 v53, v152, v117
    v_fmac_f32 v54, v152, v118
    v_fmac_f32 v55, v152, v119
    v_mfma_f32_32x32x16_bf16 v[80:95], a[172:175], v[132:135], v[80:95]
    v_mul_f32 v164, v52, v52
    v_mul_f32 v165, v53, v53
    v_mul_f32 v166, v54, v54
    v_mul_f32 v167, v55, v55
    v_fma_f32 v164, v164, v154, v153
    v_mfma_f32_32x32x16_bf16 v[64:79], a[176:179], v[136:139], v[64:79]
    ds_read_b128 v[128:131], v7 offset:59392
    buffer_load_dwordx4 v5, s[28:31], s88 offen offset:3072 lds
    s_lshl_b32 s4, s44, 13
    v_fma_f32 v165, v165, v154, v153
    v_fma_f32 v166, v166, v154, v153
    v_mfma_f32_32x32x16_bf16 v[80:95], a[180:183], v[136:139], v[80:95]
    s_add_u32 s41, s4, 5767168
    v_fma_f32 v167, v167, v154, v153
    v_mul_f32 v164, v164, v52
    v_mul_f32 v165, v165, v53
    v_mul_f32 v166, v166, v54
    s_waitcnt lgkmcnt(2)
    v_mfma_f32_32x32x16_bf16 v[64:79], a[184:187], v[140:143], v[64:79]
    ds_read_b128 v[132:135], v7 offset:60416
    s_add_u32 s62, s4, 5898240
    v_mul_f32 v167, v167, v55
    v_exp_f32 v164, v164
    v_fmac_f32 v60, v152, v124
    v_mfma_f32_32x32x16_bf16 v[80:95], a[188:191], v[140:143], v[80:95]
    s_lshl2_add_u32 s4, s48, s3
    v_exp_f32 v165, v165
    v_fmac_f32 v61, v152, v125
    v_exp_f32 v166, v166
    v_mfma_f32_32x32x16_bf16 v[64:79], a[192:195], v[144:147], v[64:79]
    s_lshl_b32 s4, s4, 7
    v_fmac_f32 v62, v152, v126
    v_exp_f32 v167, v167
    v_fmac_f32 v63, v152, v127
    v_fma_f32 v164, v164, v155, v155
    v_mfma_f32_32x32x16_bf16 v[80:95], a[196:199], v[144:147], v[80:95]
    s_lshl_b32 s90, s49, 13
    v_fma_f32 v165, v165, v155, v155
    s_waitcnt vmcnt(17)
    s_waitcnt lgkmcnt(0)
    s_barrier
    v_mfma_f32_32x32x16_bf16 v[64:79], a[200:203], v[148:151], v[64:79]
    ds_read_b128 v[136:139], v15 offset:32768
    ds_read_b128 v[140:143], v15 offset:33792
    s_add_u32 m0, s97, 0
    s_nop 0
    buffer_load_dwordx4 v28, s[36:39], s65 offen sc1 lds
    s_waitcnt vmcnt(14)
    v_mfma_f32_32x32x16_bf16 v[80:95], a[204:207], v[148:151], v[80:95]
    ds_read_b128 v[156:159], v22 offset:512
    ds_read_b64_tr_b16 v[176:177], v16
    ds_read_b64_tr_b16 v[178:179], v16 offset:1024
    s_add_u32 s90, s90, s4
    v_fma_f32 v166, v166, v155, v155
    v_fma_f32 v167, v167, v155, v155
    v_rcp_f32 v164, v164
    v_mfma_f32_32x32x16_bf16 v[64:79], a[208:211], v[128:131], v[64:79]
    ds_read_b128 v[144:147], v15 offset:34816
    buffer_load_dwordx4 v28, s[36:39], s66 offen offset:1024 sc1 lds
    ds_read_b64_tr_b16 v[180:181], v17
    s_add_u32 s90, s90, 5767168
    v_mul_f32 v60, v60, v52
    v_rcp_f32 v165, v165
    v_mul_f32 v61, v61, v53
    v_mfma_f32_32x32x16_bf16 v[80:95], a[212:215], v[128:131], v[80:95]
    ds_read_b64 v[172:173], v14 offset:32768
    ds_read_b64_tr_b16 v[182:183], v17 offset:1024
    s_mul_i32 s4, s3, 14
    v_rcp_f32 v166, v166
    v_mul_f32 v62, v62, v54
    v_rcp_f32 v167, v167
    s_waitcnt lgkmcnt(8)
    v_mfma_f32_32x32x16_bf16 v[64:79], a[216:219], v[132:135], v[64:79]
    ds_read_b128 v[148:151], v15 offset:35840
    buffer_load_dwordx4 v28, s[36:39], s67 offen offset:2048 sc1 lds
    ds_read_b64_tr_b16 v[184:185], v18
    v_mul_f32 v63, v63, v55
    v_mul_f32 v60, v60, v164
    v_mul_f32 v61, v61, v165
    v_mul_f32 v62, v62, v166
    v_mul_f32 v63, v63, v167
    v_cvt_pk_bf16_f32 v50, v60, v61
    v_cvt_pk_bf16_f32 v51, v62, v63
    buffer_store_dwordx4 v[48:51], v15, s[36:39], s7 offen offset:1024 sc1
    v_mfma_f32_32x32x16_bf16 v[80:95], a[220:223], v[132:135], v[80:95]
    ds_read_b64_tr_b16 v[186:187], v18 offset:1024
    ds_read_b64_tr_b16 v[188:189], v19
    v_min_u32 v25, 13, v1
    v_add_lshl_u32 v25, v25, s4, 7
    v_mfma_f32_32x32x16_bf16 v[32:47], a[0:3], v[136:139], 0
    ds_read_b128 v[128:131], v15 offset:36864
    buffer_load_dwordx4 v28, s[36:39], s68 offen offset:3072 sc1 lds
    ds_read_b64_tr_b16 v[190:191], v19 offset:1024
    v_mov_b32 v24, s40
    v_mfma_f32_32x32x16_bf16 v[48:63], a[4:7], v[136:139], 0
    s_waitcnt vmcnt(14)
    v_lshlrev_b32 v6, 2, v1
    s_waitcnt lgkmcnt(9)
    v_mfma_f32_32x32x16_bf16 v[32:47], a[8:11], v[140:143], v[32:47]
    ds_read_b128 v[132:135], v15 offset:37888
    s_add_u32 m0, s97, 4096
    s_nop 0
    buffer_load_dwordx4 v28, s[36:39], s69 offen sc1 lds
    ds_read_b64_tr_b16 v[192:193], v16 offset:16384
    s_add_u32 s7, s91, 114688
    v_mfma_f32_32x32x16_bf16 v[48:63], a[12:15], v[140:143], v[48:63]
    ds_read_b64_tr_b16 v[194:195], v16 offset:17408
    s_mov_b32 s60, 692224
    v_fmac_f32 v64, v156, v96
    v_fmac_f32 v65, v156, v97
    v_fmac_f32 v66, v156, v98
    v_fmac_f32 v67, v156, v99
    v_mfma_f32_32x32x16_bf16 v[32:47], a[16:19], v[144:147], v[32:47]
    ds_read_b128 v[136:139], v15 offset:38912
    buffer_load_dwordx4 v28, s[36:39], s70 offen offset:1024 sc1 lds
    ds_read_b64_tr_b16 v[196:197], v17 offset:16384
    ds_read_b64_tr_b16 v[198:199], v17 offset:17408
    s_mov_b32 s61, 696320
    v_mul_f32 v160, v64, v64
    v_mfma_f32_32x32x16_bf16 v[48:63], a[20:23], v[144:147], v[48:63]
    ds_read_b64_tr_b16 v[200:201], v18 offset:16384
    v_mul_f32 v161, v65, v65
    v_mul_f32 v162, v66, v66
    v_mul_f32 v163, v67, v67
    v_fma_f32 v160, v160, v158, v157
    s_waitcnt lgkmcnt(8)
    v_mfma_f32_32x32x16_bf16 v[32:47], a[24:27], v[148:151], v[32:47]
    ds_read_b128 v[140:143], v15 offset:39936
    buffer_load_dwordx4 v28, s[36:39], s71 offen offset:2048 sc1 lds
    ds_read_b64_tr_b16 v[202:203], v18 offset:17408
    v_fma_f32 v161, v161, v158, v157
    v_fma_f32 v162, v162, v158, v157
    v_fma_f32 v163, v163, v158, v157
    v_mfma_f32_32x32x16_bf16 v[48:63], a[28:31], v[148:151], v[48:63]
    ds_read_b64_tr_b16 v[204:205], v19 offset:16384
    v_mul_f32 v160, v160, v64
    v_mul_f32 v161, v161, v65
    v_mul_f32 v162, v162, v66
    v_mul_f32 v163, v163, v67
    v_mov_b32 v9, s44
    v_mfma_f32_32x32x16_bf16 v[32:47], a[32:35], v[128:131], v[32:47]
    ds_read_b128 v[144:147], v15 offset:40960
    s_add_u32 m0, s53, 131072
    s_add_u32 s88, s92, 200704
    buffer_load_dwordx4 v2, s[28:31], s88 offen lds
    ds_read_b64_tr_b16 v[206:207], v19 offset:17408
    v_exp_f32 v160, v160
    v_fmac_f32 v72, v156, v104
    v_exp_f32 v161, v161
    v_mfma_f32_32x32x16_bf16 v[48:63], a[36:39], v[128:131], v[48:63]
    s_waitcnt lgkmcnt(0)
    v_fmac_f32 v73, v156, v105
    v_exp_f32 v162, v162
    v_fmac_f32 v74, v156, v106
    v_mfma_f32_32x32x16_bf16 v[32:47], a[40:43], v[132:135], v[32:47]
    ds_read_b128 v[148:151], v15 offset:41984
    buffer_load_dwordx4 v3, s[28:31], s88 offen offset:1024 lds
    v_exp_f32 v163, v163
    v_fmac_f32 v75, v156, v107
    v_fma_f32 v160, v160, v159, v159
    v_mfma_f32_32x32x16_bf16 v[48:63], a[44:47], v[132:135], v[48:63]
    v_fma_f32 v161, v161, v159, v159
    v_fma_f32 v162, v162, v159, v159
    v_fma_f32 v163, v163, v159, v159
    v_rcp_f32 v160, v160
    v_mfma_f32_32x32x16_bf16 v[32:47], a[48:51], v[136:139], v[32:47]
    ds_read_b128 v[128:131], v15 offset:43008
    buffer_load_dwordx4 v4, s[28:31], s88 offen offset:2048 lds
    v_mul_f32 v72, v72, v64
    v_rcp_f32 v161, v161
    v_mul_f32 v73, v73, v65
    v_mfma_f32_32x32x16_bf16 v[48:63], a[52:55], v[136:139], v[48:63]
    v_rcp_f32 v162, v162
    v_mul_f32 v74, v74, v66
    v_rcp_f32 v163, v163
    v_mov_b32 v8, s49
    v_mfma_f32_32x32x16_bf16 v[32:47], a[56:59], v[140:143], v[32:47]
    ds_read_b128 v[132:135], v15 offset:44032
    v_mul_f32 v75, v75, v67
    v_mul_f32 v72, v72, v160
    v_mul_f32 v73, v73, v161
    v_mul_f32 v74, v74, v162
    v_mul_f32 v75, v75, v163
    v_cndmask_b32 v9, v9, v8, s[0:1]
    v_mfma_f32_32x32x16_bf16 v[48:63], a[60:63], v[140:143], v[48:63]
    buffer_load_dwordx4 v5, s[28:31], s88 offen offset:3072 lds
    v_cvt_pk_bf16_f32 v64, v72, v73
    v_cvt_pk_bf16_f32 v65, v74, v75
    v_fmac_f32 v68, v156, v100
    v_fmac_f32 v69, v156, v101
    v_and_b32 v8, 1, v1
    v_lshl_add_u32 v9, v9, 1, v8
    v_lshlrev_b32 v9, 7, v9
    v_lshrrev_b32 v26, 4, v1
    v_and_b32 v27, 0xf0, v15
    v_lshl_add_u32 v26, v26, 9, v27
    v_mfma_f32_32x32x16_bf16 v[32:47], a[64:67], v[144:147], v[32:47]
    ds_read_b128 v[136:139], v15 offset:45056
    s_add_u32 m0, s53, 98304
    s_add_u32 s88, s92, 172032
    buffer_load_dwordx4 v2, s[28:31], s88 offen lds
    v_fmac_f32 v70, v156, v102
    v_fmac_f32 v71, v156, v103
    v_mfma_f32_32x32x16_bf16 v[48:63], a[68:71], v[144:147], v[48:63]
    v_mul_f32 v164, v68, v68
    v_mul_f32 v165, v69, v69
    v_mul_f32 v166, v70, v70
    v_mul_f32 v167, v71, v71
    v_fma_f32 v164, v164, v158, v157
    s_waitcnt lgkmcnt(2)
    v_mfma_f32_32x32x16_bf16 v[32:47], a[72:75], v[148:151], v[32:47]
    ds_read_b128 v[140:143], v15 offset:46080
    s_waitcnt vmcnt(17)
    ds_read_b64_tr_b16 v[208:209], v10 offset:32768
    v_fma_f32 v165, v165, v158, v157
    v_fma_f32 v166, v166, v158, v157
    v_mfma_f32_32x32x16_bf16 v[48:63], a[76:79], v[148:151], v[48:63]
    buffer_load_dwordx4 v3, s[28:31], s88 offen offset:1024 lds
    ds_read_b64_tr_b16 v[210:211], v10 offset:33792
    v_fma_f32 v167, v167, v158, v157
    v_mul_f32 v164, v164, v68
    v_mul_f32 v165, v165, v69
    v_mul_f32 v166, v166, v70
    v_mfma_f32_32x32x16_bf16 v[32:47], a[80:83], v[128:131], v[32:47]
    ds_read_b128 v[144:147], v15 offset:47104
    ds_read_b64_tr_b16 v[212:213], v11 offset:32768
    v_mul_f32 v167, v167, v71
    v_exp_f32 v164, v164
    v_fmac_f32 v76, v156, v108
    v_mfma_f32_32x32x16_bf16 v[48:63], a[84:87], v[128:131], v[48:63]
    buffer_load_dwordx4 v4, s[28:31], s88 offen offset:2048 lds
    ds_read_b64_tr_b16 v[214:215], v11 offset:33792
    v_exp_f32 v165, v165
    v_fmac_f32 v77, v156, v109
    s_waitcnt lgkmcnt(6)
    v_mfma_f32_32x32x16_bf16 v[32:47], a[88:91], v[132:135], v[32:47]
    ds_read_b128 v[148:151], v15 offset:48128
    ds_read_b64_tr_b16 v[216:217], v12 offset:32768
    s_waitcnt vmcnt(11)
    s_add_u32 s6, s90, 0
    v_exp_f32 v166, v166
    s_mov_b32 exec_hi, 0
    buffer_store_dword v24, v6, s[36:39], s6 offen sc1
    s_mov_b64 exec, -1
    v_mfma_f32_32x32x16_bf16 v[48:63], a[92:95], v[132:135], v[48:63]
    buffer_load_dwordx4 v5, s[28:31], s88 offen offset:3072 lds
    ds_read_b64_tr_b16 v[218:219], v12 offset:33792
    ds_read_b64_tr_b16 v[220:221], v13 offset:32768
    v_fmac_f32 v78, v156, v110
    v_exp_f32 v167, v167
    v_fmac_f32 v79, v156, v111
    v_mfma_f32_32x32x16_bf16 v[32:47], a[96:99], v[136:139], v[32:47]
    ds_read_b128 v[128:131], v15 offset:49152
    ds_read_b64_tr_b16 v[222:223], v13 offset:33792
    v_fma_f32 v164, v164, v159, v159
    v_fma_f32 v165, v165, v159, v159
    v_fma_f32 v166, v166, v159, v159
    v_mfma_f32_32x32x16_bf16 v[48:63], a[100:103], v[136:139], v[48:63]
    s_add_u32 m0, s53, 114688
    s_add_u32 s88, s92, 229376
    buffer_load_dwordx4 v2, s[28:31], s88 offen lds
    v_fma_f32 v167, v167, v159, v159
    v_rcp_f32 v164, v164
    v_mul_f32 v76, v76, v68
    s_waitcnt lgkmcnt(8)
    v_mfma_f32_32x32x16_bf16 v[32:47], a[104:107], v[140:143], v[32:47]
    ds_read_b128 v[132:135], v15 offset:50176
    ds_read_b64_tr_b16 v[224:225], v10 offset:49152
    v_rcp_f32 v165, v165
    v_mul_f32 v77, v77, v69
    v_rcp_f32 v166, v166
    v_mfma_f32_32x32x16_bf16 v[48:63], a[108:111], v[140:143], v[48:63]
    buffer_load_dwordx4 v3, s[28:31], s88 offen offset:1024 lds
    ds_read_b64_tr_b16 v[226:227], v10 offset:50176
    v_mul_f32 v78, v78, v70
    v_rcp_f32 v167, v167
    v_mul_f32 v79, v79, v71
    v_mfma_f32_32x32x16_bf16 v[32:47], a[112:115], v[144:147], v[32:47]
    ds_read_b128 v[136:139], v15 offset:51200
    ds_read_b64_tr_b16 v[228:229], v11 offset:49152
    ds_read_b64_tr_b16 v[230:231], v11 offset:50176
    v_mul_f32 v76, v76, v164
    v_mul_f32 v77, v77, v165
    v_mul_f32 v78, v78, v166
    v_mfma_f32_32x32x16_bf16 v[48:63], a[116:119], v[144:147], v[48:63]
    buffer_load_dwordx4 v4, s[28:31], s88 offen offset:2048 lds
    ds_read_b64_tr_b16 v[232:233], v12 offset:49152
    v_mul_f32 v79, v79, v167
    v_cvt_pk_bf16_f32 v66, v76, v77
    v_cvt_pk_bf16_f32 v67, v78, v79
    s_waitcnt lgkmcnt(8)
    v_mfma_f32_32x32x16_bf16 v[32:47], a[120:123], v[148:151], v[32:47]
    ds_read_b128 v[140:143], v15 offset:52224
    ds_read_b64_tr_b16 v[234:235], v12 offset:50176
    buffer_store_dwordx4 v[64:67], v15, s[36:39], s7 offen sc1
    v_fmac_f32 v80, v156, v112
    v_fmac_f32 v81, v156, v113
    v_fmac_f32 v82, v156, v114
    v_fmac_f32 v83, v156, v115
    v_mfma_f32_32x32x16_bf16 v[48:63], a[124:127], v[148:151], v[48:63]
    ds_read_b64_tr_b16 v[236:237], v13 offset:49152
    v_mul_f32 v160, v80, v80
    v_mul_f32 v161, v81, v81
    v_mul_f32 v162, v82, v82
    v_mul_f32 v163, v83, v83
    v_fma_f32 v160, v160, v158, v157
    v_mfma_f32_32x32x16_bf16 v[32:47], a[128:131], v[128:131], v[32:47]
    ds_read_b128 v[144:147], v15 offset:53248
    buffer_load_dwordx4 v5, s[28:31], s88 offen offset:3072 lds
    ds_read_b64_tr_b16 v[238:239], v13 offset:50176
    v_fma_f32 v161, v161, v158, v157
    v_fma_f32 v162, v162, v158, v157
    v_mfma_f32_32x32x16_bf16 v[48:63], a[132:135], v[128:131], v[48:63]
    s_waitcnt lgkmcnt(0)
    v_fma_f32 v163, v163, v158, v157
    v_mul_f32 v160, v160, v80
    v_mul_f32 v161, v161, v81
    v_mul_f32 v162, v162, v82
    v_mfma_f32_32x32x16_bf16 v[32:47], a[136:139], v[132:135], v[32:47]
    ds_read_b128 v[148:151], v15 offset:54272
    s_add_u32 m0, s53, 65536
    s_add_u32 s88, s92, 258048
    buffer_load_dwordx4 v2, s[28:31], s88 offen lds
    v_mul_f32 v163, v163, v83
    v_exp_f32 v160, v160
    v_fmac_f32 v88, v156, v120
    v_mfma_f32_32x32x16_bf16 v[48:63], a[140:143], v[132:135], v[48:63]
    v_exp_f32 v161, v161
    v_fmac_f32 v89, v156, v121
    v_exp_f32 v162, v162
    v_fmac_f32 v90, v156, v122
    v_mfma_f32_32x32x16_bf16 v[32:47], a[144:147], v[136:139], v[32:47]
    ds_read_b128 v[128:131], v15 offset:55296
    buffer_load_dwordx4 v3, s[28:31], s88 offen offset:1024 lds
    v_exp_f32 v163, v163
    v_fmac_f32 v91, v156, v123
    v_fma_f32 v160, v160, v159, v159
    v_mfma_f32_32x32x16_bf16 v[48:63], a[148:151], v[136:139], v[48:63]
    v_fma_f32 v161, v161, v159, v159
    v_fma_f32 v162, v162, v159, v159
    v_fma_f32 v163, v163, v159, v159
    v_mfma_f32_32x32x16_bf16 v[32:47], a[152:155], v[140:143], v[32:47]
    ds_read_b128 v[132:135], v15 offset:56320
    v_rcp_f32 v160, v160
    v_mul_f32 v88, v88, v80
    v_rcp_f32 v161, v161
    v_mfma_f32_32x32x16_bf16 v[48:63], a[156:159], v[140:143], v[48:63]
    buffer_load_dwordx4 v4, s[28:31], s88 offen offset:2048 lds
    v_mul_f32 v89, v89, v81
    v_rcp_f32 v162, v162
    v_mul_f32 v90, v90, v82
    v_mfma_f32_32x32x16_bf16 v[32:47], a[160:163], v[144:147], v[32:47]
    ds_read_b128 v[136:139], v15 offset:57344
    v_rcp_f32 v163, v163
    v_mul_f32 v91, v91, v83
    v_mul_f32 v88, v88, v160
    v_mul_f32 v89, v89, v161
    v_mfma_f32_32x32x16_bf16 v[48:63], a[164:167], v[144:147], v[48:63]
    buffer_load_dwordx4 v5, s[28:31], s88 offen offset:3072 lds
    v_mul_f32 v90, v90, v162
    v_mul_f32 v91, v91, v163
    v_cvt_pk_bf16_f32 v80, v88, v89
    s_waitcnt lgkmcnt(2)
    v_mfma_f32_32x32x16_bf16 v[32:47], a[168:171], v[148:151], v[32:47]
    ds_read_b128 v[140:143], v15 offset:58368
    v_cvt_pk_bf16_f32 v81, v90, v91
    v_fmac_f32 v84, v156, v116
    v_fmac_f32 v85, v156, v117
    v_fmac_f32 v86, v156, v118
    v_fmac_f32 v87, v156, v119
    v_mfma_f32_32x32x16_bf16 v[48:63], a[172:175], v[148:151], v[48:63]
    v_mul_f32 v164, v84, v84
    v_mul_f32 v165, v85, v85
    v_mul_f32 v166, v86, v86
    v_mul_f32 v167, v87, v87
    v_fma_f32 v164, v164, v158, v157
    v_mfma_f32_32x32x16_bf16 v[32:47], a[176:179], v[128:131], v[32:47]
    ds_read_b128 v[144:147], v15 offset:59392
    s_add_u32 m0, s53, 81920
    s_add_u32 s88, s92, 286720
    buffer_load_dwordx4 v2, s[28:31], s88 offen lds
    buffer_load_dword v21, v9, s[36:39], s60 offen sc1
    v_fma_f32 v165, v165, v158, v157
    v_mfma_f32_32x32x16_bf16 v[48:63], a[180:183], v[128:131], v[48:63]
    v_fma_f32 v166, v166, v158, v157
    v_fma_f32 v167, v167, v158, v157
    v_mul_f32 v164, v164, v84
    v_mul_f32 v165, v165, v85
    s_waitcnt lgkmcnt(2)
    v_mfma_f32_32x32x16_bf16 v[32:47], a[184:187], v[132:135], v[32:47]
    ds_read_b128 v[148:151], v15 offset:60416
    v_mul_f32 v166, v166, v86
    v_mul_f32 v167, v167, v87
    v_exp_f32 v164, v164
    v_fmac_f32 v92, v156, v124
    v_mfma_f32_32x32x16_bf16 v[48:63], a[188:191], v[132:135], v[48:63]
    buffer_load_dwordx4 v3, s[28:31], s88 offen offset:1024 lds
    v_exp_f32 v165, v165
    v_fmac_f32 v93, v156, v125
    v_exp_f32 v166, v166
    v_mfma_f32_32x32x16_bf16 v[32:47], a[192:195], v[136:139], v[32:47]
    v_fmac_f32 v94, v156, v126
    v_exp_f32 v167, v167
    v_fmac_f32 v95, v156, v127
    v_fma_f32 v164, v164, v159, v159
    v_mfma_f32_32x32x16_bf16 v[48:63], a[196:199], v[136:139], v[48:63]
    buffer_load_dwordx4 v4, s[28:31], s88 offen offset:2048 lds
    v_fma_f32 v165, v165, v159, v159
    s_waitcnt vmcnt(22)
    s_waitcnt lgkmcnt(0)
    s_barrier
    v_mfma_f32_32x32x16_bf16 v[32:47], a[200:203], v[140:143], v[32:47]
    ds_read_b128 v[128:131], v15
    ds_read_b128 v[132:135], v15 offset:1024
    v_fma_f32 v166, v166, v159, v159
    v_fma_f32 v167, v167, v159, v159
    v_mfma_f32_32x32x16_bf16 v[48:63], a[204:207], v[140:143], v[48:63]
    ds_read_b128 v[152:155], v22 offset:1024
    v_rcp_f32 v164, v164
    v_mul_f32 v92, v92, v84
    v_rcp_f32 v165, v165
    v_mfma_f32_32x32x16_bf16 v[32:47], a[208:211], v[144:147], v[32:47]
    ds_read_b128 v[136:139], v15 offset:2048
    buffer_load_dwordx4 v5, s[28:31], s88 offen offset:3072 lds
    v_mul_f32 v93, v93, v85
    v_rcp_f32 v166, v166
    v_mul_f32 v94, v94, v86
    v_mfma_f32_32x32x16_bf16 v[48:63], a[212:215], v[144:147], v[48:63]
    ds_read_b64 v[174:175], v14
    v_rcp_f32 v167, v167
    v_mul_f32 v95, v95, v87
    v_mul_f32 v92, v92, v164
    s_waitcnt lgkmcnt(4)
    v_mfma_f32_32x32x16_bf16 v[32:47], a[216:219], v[148:151], v[32:47]
    ds_read_b128 v[140:143], v15 offset:3072
    s_add_u32 m0, s53, 32768
    s_add_u32 s88, s92, 315392
    buffer_load_dwordx4 v2, s[28:31], s88 offen lds
    s_waitcnt vmcnt(15)
    ds_read_b64_tr_b16 v[240:241], v16
    v_mul_f32 v93, v93, v165
    v_mul_f32 v94, v94, v166
    v_mul_f32 v95, v95, v167
    v_cvt_pk_bf16_f32 v82, v92, v93
    v_cvt_pk_bf16_f32 v83, v94, v95
    buffer_store_dwordx4 v[80:83], v15, s[36:39], s7 offen offset:1024 sc1
    v_mfma_f32_32x32x16_bf16 v[48:63], a[220:223], v[148:151], v[48:63]
    ds_read_b64_tr_b16 v[242:243], v16 offset:1024
    v_mfma_f32_32x32x16_bf16 v[64:79], a[0:3], v[128:131], 0
    ds_read_b128 v[144:147], v15 offset:4096
    buffer_load_dwordx4 v3, s[28:31], s88 offen offset:1024 lds
    ds_read_b64_tr_b16 v[244:245], v17
    v_mfma_f32_32x32x16_bf16 v[80:95], a[4:7], v[128:131], 0
    ds_read_b64_tr_b16 v[246:247], v17 offset:1024
    s_waitcnt lgkmcnt(7)
    v_mfma_f32_32x32x16_bf16 v[64:79], a[8:11], v[132:135], v[64:79]
    ds_read_b128 v[148:151], v15 offset:5120
    buffer_load_dwordx4 v4, s[28:31], s88 offen offset:2048 lds
    ds_read_b64_tr_b16 v[248:249], v18
    ds_read_b64_tr_b16 v[250:251], v18 offset:1024
    s_add_u32 s7, s91, 229376
    v_fmac_f32 v32, v152, v96
    v_mfma_f32_32x32x16_bf16 v[80:95], a[12:15], v[132:135], v[80:95]
    ds_read_b64_tr_b16 v[252:253], v19
    v_fmac_f32 v33, v152, v97
    v_fmac_f32 v34, v152, v98
    v_fmac_f32 v35, v152, v99
    v_mul_f32 v160, v32, v32
    v_mul_f32 v161, v33, v33
    v_mfma_f32_32x32x16_bf16 v[64:79], a[16:19], v[136:139], v[64:79]
    ds_read_b128 v[128:131], v15 offset:6144
    ds_read_b64_tr_b16 v[254:255], v19 offset:1024
    v_mul_f32 v162, v34, v34
    v_mul_f32 v163, v35, v35
    v_fma_f32 v160, v160, v154, v153
    v_mfma_f32_32x32x16_bf16 v[80:95], a[20:23], v[136:139], v[80:95]
    buffer_load_dwordx4 v5, s[28:31], s88 offen offset:3072 lds
    s_waitcnt lgkmcnt(0)
    v_fma_f32 v161, v161, v154, v153
    v_fma_f32 v162, v162, v154, v153
    v_mfma_f32_32x32x16_bf16 v[64:79], a[24:27], v[140:143], v[64:79]
    ds_read_b128 v[132:135], v15 offset:7168
    v_fma_f32 v163, v163, v154, v153
    v_mul_f32 v160, v160, v32
    v_mul_f32 v161, v161, v33
    v_mul_f32 v162, v162, v34
    v_mul_f32 v163, v163, v35
    v_mfma_f32_32x32x16_bf16 v[80:95], a[28:31], v[140:143], v[80:95]
    s_add_u32 m0, s53, 49152
    s_add_u32 s88, s92, 344064
    buffer_load_dwordx4 v2, s[28:31], s88 offen lds
    v_exp_f32 v160, v160
    v_fmac_f32 v40, v152, v104
    v_exp_f32 v161, v161
    v_mfma_f32_32x32x16_bf16 v[64:79], a[32:35], v[144:147], v[64:79]
    ds_read_b128 v[136:139], v15 offset:8192
    v_fmac_f32 v41, v152, v105
    v_exp_f32 v162, v162
    v_fmac_f32 v42, v152, v106
    v_mfma_f32_32x32x16_bf16 v[80:95], a[36:39], v[144:147], v[80:95]
    buffer_load_dwordx4 v3, s[28:31], s88 offen offset:1024 lds
    v_exp_f32 v163, v163
    v_fmac_f32 v43, v152, v107
    v_fma_f32 v160, v160, v155, v155
    v_mfma_f32_32x32x16_bf16 v[64:79], a[40:43], v[148:151], v[64:79]
    ds_read_b128 v[140:143], v15 offset:9216
    v_fma_f32 v161, v161, v155, v155
    v_fma_f32 v162, v162, v155, v155
    v_fma_f32 v163, v163, v155, v155
    v_rcp_f32 v160, v160
    v_mfma_f32_32x32x16_bf16 v[80:95], a[44:47], v[148:151], v[80:95]
    v_mul_f32 v40, v40, v32
    v_rcp_f32 v161, v161
    v_mul_f32 v41, v41, v33
    v_rcp_f32 v162, v162
    v_mfma_f32_32x32x16_bf16 v[64:79], a[48:51], v[128:131], v[64:79]
    ds_read_b128 v[144:147], v15 offset:10240
    buffer_load_dwordx4 v4, s[28:31], s88 offen offset:2048 lds
    v_mul_f32 v42, v42, v34
    v_rcp_f32 v163, v163
    v_mul_f32 v43, v43, v35
    v_mfma_f32_32x32x16_bf16 v[80:95], a[52:55], v[128:131], v[80:95]
    s_waitcnt vmcnt(11)
    v_cmp_ne_u32 vcc, s40, v21
    s_cbranch_vccnz L_cc_74
L_cb_75:
    v_mul_f32 v40, v40, v160
    v_mul_f32 v41, v41, v161
    v_mul_f32 v42, v42, v162
    s_waitcnt lgkmcnt(2)
    v_mfma_f32_32x32x16_bf16 v[64:79], a[56:59], v[132:135], v[64:79]
    ds_read_b128 v[148:151], v15 offset:11264
    buffer_load_dwordx4 v5, s[28:31], s88 offen offset:3072 lds
    v_mul_f32 v43, v43, v163
    v_cvt_pk_bf16_f32 v32, v40, v41
    v_cvt_pk_bf16_f32 v33, v42, v43
    v_fmac_f32 v36, v152, v100
    v_mfma_f32_32x32x16_bf16 v[80:95], a[60:63], v[132:135], v[80:95]
    v_fmac_f32 v37, v152, v101
    v_fmac_f32 v38, v152, v102
    v_fmac_f32 v39, v152, v103
    v_mul_f32 v164, v36, v36
    v_mul_f32 v165, v37, v37
    v_mul_f32 v166, v38, v38
    v_mfma_f32_32x32x16_bf16 v[64:79], a[64:67], v[136:139], v[64:79]
    ds_read_b128 v[128:131], v15 offset:12288
    s_add_u32 m0, s53, 98304
    s_add_u32 s88, s92, 372736
    buffer_load_dwordx4 v2, s[28:31], s88 offen lds
    buffer_load_dword v23, v25, s[36:39], s41 offen sc1
    v_mul_f32 v167, v39, v39
    v_fma_f32 v164, v164, v154, v153
    v_fma_f32 v165, v165, v154, v153
    v_mfma_f32_32x32x16_bf16 v[80:95], a[68:71], v[136:139], v[80:95]
    v_fma_f32 v166, v166, v154, v153
    v_fma_f32 v167, v167, v154, v153
    v_mul_f32 v164, v164, v36
    v_mul_f32 v165, v165, v37
    s_waitcnt lgkmcnt(2)
    v_mfma_f32_32x32x16_bf16 v[64:79], a[72:75], v[140:143], v[64:79]
    ds_read_b128 v[132:135], v15 offset:13312
    buffer_load_dwordx4 v3, s[28:31], s88 offen offset:1024 lds
    v_mul_f32 v166, v166, v38
    v_mul_f32 v167, v167, v39
    v_exp_f32 v164, v164
    v_mfma_f32_32x32x16_bf16 v[80:95], a[76:79], v[140:143], v[80:95]
    v_fmac_f32 v44, v152, v108
    v_exp_f32 v165, v165
    v_fmac_f32 v45, v152, v109
    v_exp_f32 v166, v166
    v_mfma_f32_32x32x16_bf16 v[64:79], a[80:83], v[144:147], v[64:79]
    ds_read_b128 v[136:139], v15 offset:14336
    v_fmac_f32 v46, v152, v110
    v_exp_f32 v167, v167
    v_fmac_f32 v47, v152, v111
    v_fma_f32 v164, v164, v155, v155
    v_mfma_f32_32x32x16_bf16 v[80:95], a[84:87], v[144:147], v[80:95]
    buffer_load_dwordx4 v4, s[28:31], s88 offen offset:2048 lds
    v_fma_f32 v165, v165, v155, v155
    v_fma_f32 v166, v166, v155, v155
    v_fma_f32 v167, v167, v155, v155
    s_waitcnt lgkmcnt(2)
    v_mfma_f32_32x32x16_bf16 v[64:79], a[88:91], v[148:151], v[64:79]
    ds_read_b128 v[140:143], v15 offset:15360
    s_waitcnt vmcnt(11)
    s_add_u32 s6, s90, 131072
    s_mov_b32 exec_hi, 0
    buffer_store_dword v24, v6, s[36:39], s6 offen sc1
    s_mov_b64 exec, -1
    v_rcp_f32 v164, v164
    v_mul_f32 v44, v44, v36
    v_rcp_f32 v165, v165
    v_mfma_f32_32x32x16_bf16 v[80:95], a[92:95], v[148:151], v[80:95]
    buffer_load_dwordx4 v5, s[28:31], s88 offen offset:3072 lds
    v_mul_f32 v45, v45, v37
    v_rcp_f32 v166, v166
    v_mul_f32 v46, v46, v38
    v_mfma_f32_32x32x16_bf16 v[64:79], a[96:99], v[128:131], v[64:79]
    ds_read_b128 v[144:147], v15 offset:16384
    v_rcp_f32 v167, v167
    v_mul_f32 v47, v47, v39
    v_mul_f32 v44, v44, v164
    v_mul_f32 v45, v45, v165
    v_mfma_f32_32x32x16_bf16 v[80:95], a[100:103], v[128:131], v[80:95]
    v_mul_f32 v46, v46, v166
    v_mul_f32 v47, v47, v167
    v_cvt_pk_bf16_f32 v34, v44, v45
    v_cvt_pk_bf16_f32 v35, v46, v47
    s_waitcnt lgkmcnt(2)
    v_mfma_f32_32x32x16_bf16 v[64:79], a[104:107], v[132:135], v[64:79]
    ds_read_b128 v[148:151], v15 offset:17408
    buffer_store_dwordx4 v[32:35], v15, s[36:39], s7 offen sc1
    v_fmac_f32 v48, v152, v112
    v_fmac_f32 v49, v152, v113
    v_fmac_f32 v50, v152, v114
    v_fmac_f32 v51, v152, v115
    v_mfma_f32_32x32x16_bf16 v[80:95], a[108:111], v[132:135], v[80:95]
    v_mul_f32 v160, v48, v48
    v_mul_f32 v161, v49, v49
    v_mul_f32 v162, v50, v50
    v_mul_f32 v163, v51, v51
    v_fma_f32 v160, v160, v154, v153
    v_mfma_f32_32x32x16_bf16 v[64:79], a[112:115], v[136:139], v[64:79]
    ds_read_b128 v[128:131], v15 offset:18432
    v_fma_f32 v161, v161, v154, v153
    v_fma_f32 v162, v162, v154, v153
    v_fma_f32 v163, v163, v154, v153
    v_mul_f32 v160, v160, v48
    v_mfma_f32_32x32x16_bf16 v[80:95], a[116:119], v[136:139], v[80:95]
    v_mul_f32 v161, v161, v49
    v_mul_f32 v162, v162, v50
    v_mul_f32 v163, v163, v51
    v_exp_f32 v160, v160
    s_waitcnt lgkmcnt(2)
    v_mfma_f32_32x32x16_bf16 v[64:79], a[120:123], v[140:143], v[64:79]
    ds_read_b128 v[132:135], v15 offset:19456
    buffer_load_dword v21, v9, s[36:39], s61 offen sc1
    v_fmac_f32 v56, v152, v120
    v_exp_f32 v161, v161
    v_fmac_f32 v57, v152, v121
    v_mfma_f32_32x32x16_bf16 v[80:95], a[124:127], v[140:143], v[80:95]
    v_exp_f32 v162, v162
    v_fmac_f32 v58, v152, v122
    v_exp_f32 v163, v163
    v_fmac_f32 v59, v152, v123
    v_mfma_f32_32x32x16_bf16 v[64:79], a[128:131], v[144:147], v[64:79]
    ds_read_b128 v[136:139], v15 offset:20480
    v_fma_f32 v160, v160, v155, v155
    v_fma_f32 v161, v161, v155, v155
    v_fma_f32 v162, v162, v155, v155
    v_fma_f32 v163, v163, v155, v155
    v_mfma_f32_32x32x16_bf16 v[80:95], a[132:135], v[144:147], v[80:95]
    v_rcp_f32 v160, v160
    v_mul_f32 v56, v56, v48
    v_rcp_f32 v161, v161
    s_waitcnt lgkmcnt(2)
    v_mfma_f32_32x32x16_bf16 v[64:79], a[136:139], v[148:151], v[64:79]
    ds_read_b128 v[140:143], v15 offset:21504
    v_mul_f32 v57, v57, v49
    v_rcp_f32 v162, v162
    v_mul_f32 v58, v58, v50
    v_mfma_f32_32x32x16_bf16 v[80:95], a[140:143], v[148:151], v[80:95]
    v_rcp_f32 v163, v163
    v_mul_f32 v59, v59, v51
    v_mul_f32 v56, v56, v160
    v_mul_f32 v57, v57, v161
    v_mul_f32 v58, v58, v162
    v_mfma_f32_32x32x16_bf16 v[64:79], a[144:147], v[128:131], v[64:79]
    ds_read_b128 v[144:147], v15 offset:22528
    ds_read_b64_tr_b16 a[112:113], v16 offset:32768
    ds_read_b64_tr_b16 a[114:115], v16 offset:33792
    v_mul_f32 v59, v59, v163
    v_cvt_pk_bf16_f32 v48, v56, v57
    v_mfma_f32_32x32x16_bf16 v[80:95], a[148:151], v[128:131], v[80:95]
    ds_read_b64_tr_b16 a[116:117], v17 offset:32768
    ds_read_b64_tr_b16 a[118:119], v17 offset:33792
    v_cvt_pk_bf16_f32 v49, v58, v59
    v_fmac_f32 v52, v152, v116
    v_fmac_f32 v53, v152, v117
    s_waitcnt lgkmcnt(6)
    v_mfma_f32_32x32x16_bf16 v[64:79], a[152:155], v[132:135], v[64:79]
    ds_read_b128 v[148:151], v15 offset:23552
    ds_read_b64_tr_b16 a[120:121], v18 offset:32768
    ds_read_b64_tr_b16 a[122:123], v18 offset:33792
    v_fmac_f32 v54, v152, v118
    v_fmac_f32 v55, v152, v119
    v_mul_f32 v164, v52, v52
    v_mul_f32 v165, v53, v53
    v_mul_f32 v166, v54, v54
    v_mfma_f32_32x32x16_bf16 v[80:95], a[156:159], v[132:135], v[80:95]
    ds_read_b64_tr_b16 a[124:125], v19 offset:32768
    ds_read_b64_tr_b16 a[126:127], v19 offset:33792
    v_mul_f32 v167, v55, v55
    v_fma_f32 v164, v164, v154, v153
    v_fma_f32 v165, v165, v154, v153
    v_fma_f32 v166, v166, v154, v153
    v_mfma_f32_32x32x16_bf16 v[64:79], a[160:163], v[136:139], v[64:79]
    ds_read_b128 v[128:131], v15 offset:24576
    s_waitcnt vmcnt(6)
    ds_read_b64_tr_b16 a[128:129], v16 offset:16384
    ds_read_b64_tr_b16 a[130:131], v16 offset:17408
    v_cmp_ne_u32 vcc, s40, v23
    s_cbranch_vccnz L_cc_70
L_cb_71:
    v_fma_f32 v167, v167, v154, v153
    v_mul_f32 v164, v164, v52
    v_mul_f32 v165, v165, v53
    v_mul_f32 v166, v166, v54
    v_mfma_f32_32x32x16_bf16 v[80:95], a[164:167], v[136:139], v[80:95]
    buffer_load_dwordx4 a[0:3], v26, s[36:39], s79 offen sc1
    ds_read_b64_tr_b16 a[132:133], v17 offset:16384
    ds_read_b64_tr_b16 a[134:135], v17 offset:17408
    v_mul_f32 v167, v167, v55
    v_exp_f32 v164, v164
    v_fmac_f32 v60, v152, v124
    v_exp_f32 v165, v165
    s_waitcnt lgkmcnt(14)
    v_mfma_f32_32x32x16_bf16 v[64:79], a[168:171], v[140:143], v[64:79]
    ds_read_b128 v[132:135], v15 offset:25600
    ds_read_b64_tr_b16 a[136:137], v18 offset:16384
    ds_read_b64_tr_b16 a[138:139], v18 offset:17408
    v_fmac_f32 v61, v152, v125
    v_exp_f32 v166, v166
    v_fmac_f32 v62, v152, v126
    v_mfma_f32_32x32x16_bf16 v[80:95], a[172:175], v[140:143], v[80:95]
    buffer_load_dwordx4 a[4:7], v26, s[36:39], s79 offen offset:2048 sc1
    ds_read_b64_tr_b16 a[140:141], v19 offset:16384
    ds_read_b64_tr_b16 a[142:143], v19 offset:17408
    v_exp_f32 v167, v167
    v_fmac_f32 v63, v152, v127
    v_fma_f32 v164, v164, v155, v155
    v_mfma_f32_32x32x16_bf16 v[64:79], a[176:179], v[144:147], v[64:79]
    ds_read_b128 v[136:139], v15 offset:26624
    ds_read_b64_tr_b16 a[144:145], v10 offset:32768
    ds_read_b64_tr_b16 a[146:147], v10 offset:33792
    v_fma_f32 v165, v165, v155, v155
    v_fma_f32 v166, v166, v155, v155
    v_fma_f32 v167, v167, v155, v155
    v_rcp_f32 v164, v164
    v_mfma_f32_32x32x16_bf16 v[80:95], a[180:183], v[144:147], v[80:95]
    buffer_load_dwordx4 a[8:11], v26, s[36:39], s80 offen sc1
    ds_read_b64_tr_b16 a[148:149], v11 offset:32768
    ds_read_b64_tr_b16 a[150:151], v11 offset:33792
    v_mul_f32 v60, v60, v52
    v_rcp_f32 v165, v165
    v_mul_f32 v61, v61, v53
    s_waitcnt lgkmcnt(14)
    v_mfma_f32_32x32x16_bf16 v[64:79], a[184:187], v[148:151], v[64:79]
    ds_read_b128 v[140:143], v15 offset:27648
    ds_read_b64_tr_b16 a[152:153], v12 offset:32768
    ds_read_b64_tr_b16 a[154:155], v12 offset:33792
    v_rcp_f32 v166, v166
    v_mul_f32 v62, v62, v54
    v_rcp_f32 v167, v167
    v_mfma_f32_32x32x16_bf16 v[80:95], a[188:191], v[148:151], v[80:95]
    buffer_load_dwordx4 a[12:15], v26, s[36:39], s80 offen offset:2048 sc1
    ds_read_b64_tr_b16 a[156:157], v13 offset:32768
    ds_read_b64_tr_b16 a[158:159], v13 offset:33792
    v_mul_f32 v63, v63, v55
    v_mul_f32 v60, v60, v164
    v_mul_f32 v61, v61, v165
    v_mul_f32 v62, v62, v166
    v_mul_f32 v63, v63, v167
    v_cvt_pk_bf16_f32 v50, v60, v61
    v_cvt_pk_bf16_f32 v51, v62, v63
    buffer_store_dwordx4 v[48:51], v15, s[36:39], s7 offen offset:1024 sc1
    ds_read_b128 v[156:159], v22 offset:1536
    v_mfma_f32_32x32x16_bf16 v[64:79], a[192:195], v[128:131], v[64:79]
    ds_read_b64_tr_b16 a[160:161], v10 offset:49152
    ds_read_b64_tr_b16 a[162:163], v10 offset:50176
    v_mfma_f32_32x32x16_bf16 v[80:95], a[196:199], v[128:131], v[80:95]
    ds_read_b64_tr_b16 a[164:165], v11 offset:49152
    ds_read_b64_tr_b16 a[166:167], v11 offset:50176
    s_waitcnt lgkmcnt(14)
    v_mfma_f32_32x32x16_bf16 v[64:79], a[200:203], v[132:135], v[64:79]
    ds_read_b64_tr_b16 a[168:169], v12 offset:49152
    ds_read_b64_tr_b16 a[170:171], v12 offset:50176
    v_mfma_f32_32x32x16_bf16 v[80:95], a[204:207], v[132:135], v[80:95]
    ds_read_b64_tr_b16 a[172:173], v13 offset:49152
    ds_read_b64_tr_b16 a[174:175], v13 offset:50176
    v_mfma_f32_32x32x16_bf16 v[64:79], a[208:211], v[136:139], v[64:79]
    ds_read_b64_tr_b16 a[176:177], v10
    ds_read_b64_tr_b16 a[178:179], v10 offset:1024
    v_mfma_f32_32x32x16_bf16 v[80:95], a[212:215], v[136:139], v[80:95]
    ds_read_b64_tr_b16 a[180:181], v11
    ds_read_b64_tr_b16 a[182:183], v11 offset:1024
    s_waitcnt lgkmcnt(15)
    v_mfma_f32_32x32x16_bf16 v[64:79], a[216:219], v[140:143], v[64:79]
    s_waitcnt vmcnt(5)
    ds_read_b64_tr_b16 a[184:185], v12
    ds_read_b64_tr_b16 a[186:187], v12 offset:1024
    v_cmp_ne_u32 vcc, s40, v21
    s_cbranch_vccnz L_cc_76
L_cb_77:
    v_mfma_f32_32x32x16_bf16 v[80:95], a[220:223], v[140:143], v[80:95]
    ds_read_b64_tr_b16 a[188:189], v13
    ds_read_b64_tr_b16 a[190:191], v13 offset:1024
    s_waitcnt lgkmcnt(15)
    s_add_u32 s7, s91, 344064
    s_nop 1
    v_pk_fma_f32 v[64:65], v[156:157], v[96:97], v[64:65] op_sel:[0,0,0] op_sel_hi:[0,1,1]
    buffer_load_dwordx4 a[16:19], v26, s[36:39], s81 offen sc1
    buffer_load_dwordx4 a[20:23], v26, s[36:39], s81 offen offset:2048 sc1
    v_pk_fma_f32 v[66:67], v[156:157], v[98:99], v[66:67] op_sel:[0,0,0] op_sel_hi:[0,1,1]
    v_pk_fma_f32 v[68:69], v[156:157], v[100:101], v[68:69] op_sel:[0,0,0] op_sel_hi:[0,1,1]
    v_pk_fma_f32 v[70:71], v[156:157], v[102:103], v[70:71] op_sel:[0,0,0] op_sel_hi:[0,1,1]
    v_pk_mul_f32 v[160:161], v[64:65], v[64:65] op_sel:[0,0] op_sel_hi:[1,1]
    v_pk_mul_f32 v[162:163], v[66:67], v[66:67] op_sel:[0,0] op_sel_hi:[1,1]
    v_pk_mul_f32 v[164:165], v[68:69], v[68:69] op_sel:[0,0] op_sel_hi:[1,1]
    v_pk_mul_f32 v[166:167], v[70:71], v[70:71] op_sel:[0,0] op_sel_hi:[1,1]
    v_pk_fma_f32 v[160:161], v[160:161], v[158:159], v[156:157] op_sel:[0,0,1] op_sel_hi:[1,0,1]
    v_pk_fma_f32 v[162:163], v[162:163], v[158:159], v[156:157] op_sel:[0,0,1] op_sel_hi:[1,0,1]
    v_pk_fma_f32 v[164:165], v[164:165], v[158:159], v[156:157] op_sel:[0,0,1] op_sel_hi:[1,0,1]
    v_pk_fma_f32 v[166:167], v[166:167], v[158:159], v[156:157] op_sel:[0,0,1] op_sel_hi:[1,0,1]
    v_pk_mul_f32 v[160:161], v[160:161], v[64:65] op_sel:[0,0] op_sel_hi:[1,1]
    v_pk_mul_f32 v[162:163], v[162:163], v[66:67] op_sel:[0,0] op_sel_hi:[1,1]
    v_pk_mul_f32 v[164:165], v[164:165], v[68:69] op_sel:[0,0] op_sel_hi:[1,1]
    v_pk_mul_f32 v[166:167], v[166:167], v[70:71] op_sel:[0,0] op_sel_hi:[1,1]
    v_exp_f32 v160, v160
    v_exp_f32 v161, v161
    v_exp_f32 v162, v162
    buffer_load_dword v23, v25, s[36:39], s62 offen sc1
    v_exp_f32 v163, v163
    v_exp_f32 v164, v164
    v_exp_f32 v165, v165
    v_exp_f32 v166, v166
    v_exp_f32 v167, v167
    v_pk_fma_f32 v[72:73], v[156:157], v[104:105], v[72:73] op_sel:[0,0,0] op_sel_hi:[0,1,1]
    v_pk_fma_f32 v[74:75], v[156:157], v[106:107], v[74:75] op_sel:[0,0,0] op_sel_hi:[0,1,1]
    v_pk_fma_f32 v[76:77], v[156:157], v[108:109], v[76:77] op_sel:[0,0,0] op_sel_hi:[0,1,1]
    v_pk_fma_f32 v[78:79], v[156:157], v[110:111], v[78:79] op_sel:[0,0,0] op_sel_hi:[0,1,1]
    v_pk_fma_f32 v[160:161], v[160:161], v[158:159], v[158:159] op_sel:[0,1,1] op_sel_hi:[1,1,1]
    v_pk_fma_f32 v[162:163], v[162:163], v[158:159], v[158:159] op_sel:[0,1,1] op_sel_hi:[1,1,1]
    v_pk_fma_f32 v[164:165], v[164:165], v[158:159], v[158:159] op_sel:[0,1,1] op_sel_hi:[1,1,1]
    buffer_load_dwordx4 a[24:27], v26, s[36:39], s82 offen sc1
    buffer_load_dwordx4 a[28:31], v26, s[36:39], s82 offen offset:2048 sc1
    v_pk_fma_f32 v[166:167], v[166:167], v[158:159], v[158:159] op_sel:[0,1,1] op_sel_hi:[1,1,1]
    v_rcp_f32 v160, v160
    v_rcp_f32 v161, v161
    v_rcp_f32 v162, v162
    v_rcp_f32 v163, v163
    v_rcp_f32 v164, v164
    v_rcp_f32 v165, v165
    v_rcp_f32 v166, v166
    v_rcp_f32 v167, v167
    v_pk_mul_f32 v[72:73], v[72:73], v[64:65] op_sel:[0,0] op_sel_hi:[1,1]
    v_pk_mul_f32 v[74:75], v[74:75], v[66:67] op_sel:[0,0] op_sel_hi:[1,1]
    v_pk_mul_f32 v[76:77], v[76:77], v[68:69] op_sel:[0,0] op_sel_hi:[1,1]
    v_pk_mul_f32 v[78:79], v[78:79], v[70:71] op_sel:[0,0] op_sel_hi:[1,1]
    v_pk_mul_f32 v[72:73], v[72:73], v[160:161] op_sel:[0,0] op_sel_hi:[1,1]
    v_pk_mul_f32 v[74:75], v[74:75], v[162:163] op_sel:[0,0] op_sel_hi:[1,1]
    v_pk_mul_f32 v[76:77], v[76:77], v[164:165] op_sel:[0,0] op_sel_hi:[1,1]
    v_pk_mul_f32 v[78:79], v[78:79], v[166:167] op_sel:[0,0] op_sel_hi:[1,1]
    v_cvt_pk_bf16_f32 v64, v72, v73
    v_cvt_pk_bf16_f32 v65, v74, v75
    v_cvt_pk_bf16_f32 v66, v76, v77
    v_cvt_pk_bf16_f32 v67, v78, v79
    buffer_store_dwordx4 v[64:67], v15, s[36:39], s7 offen sc1
    v_pk_fma_f32 v[80:81], v[156:157], v[112:113], v[80:81] op_sel:[0,0,0] op_sel_hi:[0,1,1]
    v_pk_fma_f32 v[82:83], v[156:157], v[114:115], v[82:83] op_sel:[0,0,0] op_sel_hi:[0,1,1]
    v_pk_fma_f32 v[84:85], v[156:157], v[116:117], v[84:85] op_sel:[0,0,0] op_sel_hi:[0,1,1]
    v_pk_fma_f32 v[86:87], v[156:157], v[118:119], v[86:87] op_sel:[0,0,0] op_sel_hi:[0,1,1]
    v_pk_mul_f32 v[160:161], v[80:81], v[80:81] op_sel:[0,0] op_sel_hi:[1,1]
    v_pk_mul_f32 v[162:163], v[82:83], v[82:83] op_sel:[0,0] op_sel_hi:[1,1]
    v_pk_mul_f32 v[164:165], v[84:85], v[84:85] op_sel:[0,0] op_sel_hi:[1,1]
    v_pk_mul_f32 v[166:167], v[86:87], v[86:87] op_sel:[0,0] op_sel_hi:[1,1]
    v_pk_fma_f32 v[160:161], v[160:161], v[158:159], v[156:157] op_sel:[0,0,1] op_sel_hi:[1,0,1]
    v_pk_fma_f32 v[162:163], v[162:163], v[158:159], v[156:157] op_sel:[0,0,1] op_sel_hi:[1,0,1]
    buffer_load_dwordx4 a[32:35], v26, s[36:39], s83 offen sc1
    buffer_load_dwordx4 a[36:39], v26, s[36:39], s83 offen offset:2048 sc1
    v_pk_fma_f32 v[164:165], v[164:165], v[158:159], v[156:157] op_sel:[0,0,1] op_sel_hi:[1,0,1]
    v_pk_fma_f32 v[166:167], v[166:167], v[158:159], v[156:157] op_sel:[0,0,1] op_sel_hi:[1,0,1]
    v_pk_mul_f32 v[160:161], v[160:161], v[80:81] op_sel:[0,0] op_sel_hi:[1,1]
    v_pk_mul_f32 v[162:163], v[162:163], v[82:83] op_sel:[0,0] op_sel_hi:[1,1]
    v_pk_mul_f32 v[164:165], v[164:165], v[84:85] op_sel:[0,0] op_sel_hi:[1,1]
    v_pk_mul_f32 v[166:167], v[166:167], v[86:87] op_sel:[0,0] op_sel_hi:[1,1]
    v_exp_f32 v160, v160
    v_exp_f32 v161, v161
    v_exp_f32 v162, v162
    v_exp_f32 v163, v163
    v_exp_f32 v164, v164
    v_exp_f32 v165, v165
    v_exp_f32 v166, v166
    v_exp_f32 v167, v167
    v_pk_fma_f32 v[88:89], v[156:157], v[120:121], v[88:89] op_sel:[0,0,0] op_sel_hi:[0,1,1]
    v_pk_fma_f32 v[90:91], v[156:157], v[122:123], v[90:91] op_sel:[0,0,0] op_sel_hi:[0,1,1]
    v_pk_fma_f32 v[92:93], v[156:157], v[124:125], v[92:93] op_sel:[0,0,0] op_sel_hi:[0,1,1]
    v_pk_fma_f32 v[94:95], v[156:157], v[126:127], v[94:95] op_sel:[0,0,0] op_sel_hi:[0,1,1]
    v_pk_fma_f32 v[160:161], v[160:161], v[158:159], v[158:159] op_sel:[0,1,1] op_sel_hi:[1,1,1]
    v_pk_fma_f32 v[162:163], v[162:163], v[158:159], v[158:159] op_sel:[0,1,1] op_sel_hi:[1,1,1]
    v_pk_fma_f32 v[164:165], v[164:165], v[158:159], v[158:159] op_sel:[0,1,1] op_sel_hi:[1,1,1]
    v_pk_fma_f32 v[166:167], v[166:167], v[158:159], v[158:159] op_sel:[0,1,1] op_sel_hi:[1,1,1]
    v_rcp_f32 v160, v160
    v_rcp_f32 v161, v161
    v_rcp_f32 v162, v162
    v_rcp_f32 v163, v163
    v_rcp_f32 v164, v164
    v_rcp_f32 v165, v165
    v_rcp_f32 v166, v166
    buffer_load_dwordx4 a[40:43], v26, s[36:39], s84 offen sc1
    buffer_load_dwordx4 a[44:47], v26, s[36:39], s84 offen offset:2048 sc1
    v_rcp_f32 v167, v167
    v_pk_mul_f32 v[88:89], v[88:89], v[80:81] op_sel:[0,0] op_sel_hi:[1,1]
    v_pk_mul_f32 v[90:91], v[90:91], v[82:83] op_sel:[0,0] op_sel_hi:[1,1]
    v_pk_mul_f32 v[92:93], v[92:93], v[84:85] op_sel:[0,0] op_sel_hi:[1,1]
    v_pk_mul_f32 v[94:95], v[94:95], v[86:87] op_sel:[0,0] op_sel_hi:[1,1]
    v_pk_mul_f32 v[88:89], v[88:89], v[160:161] op_sel:[0,0] op_sel_hi:[1,1]
    v_pk_mul_f32 v[90:91], v[90:91], v[162:163] op_sel:[0,0] op_sel_hi:[1,1]
    v_pk_mul_f32 v[92:93], v[92:93], v[164:165] op_sel:[0,0] op_sel_hi:[1,1]
    v_pk_mul_f32 v[94:95], v[94:95], v[166:167] op_sel:[0,0] op_sel_hi:[1,1]
    v_cvt_pk_bf16_f32 v80, v88, v89
    v_cvt_pk_bf16_f32 v81, v90, v91
    v_cvt_pk_bf16_f32 v82, v92, v93
    v_cvt_pk_bf16_f32 v83, v94, v95
    buffer_store_dwordx4 v[80:83], v15, s[36:39], s7 offen offset:1024 sc1
    s_waitcnt vmcnt(14)
    v_mfma_f32_16x16x32_bf16 v[32:35], a[224:227], a[0:3], 0
    buffer_load_dwordx4 a[48:51], v26, s[36:39], s85 offen sc1
    v_mfma_f32_16x16x32_bf16 v[36:39], a[228:231], a[0:3], 0
    ds_read_b64_tr_b16 a[192:193], v10 offset:16384
    v_mfma_f32_16x16x32_bf16 v[40:43], a[232:235], a[0:3], 0
    ds_read_b64_tr_b16 a[194:195], v10 offset:17408
    v_mfma_f32_16x16x32_bf16 v[44:47], a[236:239], a[0:3], 0
    ds_read_b64_tr_b16 a[196:197], v11 offset:16384
    v_mfma_f32_16x16x32_bf16 v[32:35], a[240:243], a[4:7], v[32:35]
    buffer_load_dwordx4 a[52:55], v26, s[36:39], s85 offen offset:2048 sc1
    ds_read_b64_tr_b16 a[198:199], v11 offset:17408
    v_mfma_f32_16x16x32_bf16 v[36:39], a[244:247], a[4:7], v[36:39]
    ds_read_b64_tr_b16 a[200:201], v12 offset:16384
    v_mfma_f32_16x16x32_bf16 v[40:43], a[248:251], a[4:7], v[40:43]
    ds_read_b64_tr_b16 a[202:203], v12 offset:17408
    v_mfma_f32_16x16x32_bf16 v[44:47], a[252:255], a[4:7], v[44:47]
    s_waitcnt vmcnt(10)
    v_cmp_ne_u32 vcc, s40, v23
    s_cbranch_vccnz L_cc_72
L_cb_73:
    v_add_u32 v26, 114688, v26
    v_mfma_f32_16x16x32_bf16 v[32:35], v[176:179], a[8:11], v[32:35]
    buffer_load_dwordx4 a[56:59], v26, s[36:39], s79 offen sc1
    ds_read_b64_tr_b16 a[204:205], v13 offset:16384
    v_mfma_f32_16x16x32_bf16 v[36:39], v[180:183], a[8:11], v[36:39]
    ds_read_b64_tr_b16 a[206:207], v13 offset:17408
    v_mfma_f32_16x16x32_bf16 v[40:43], v[184:187], a[8:11], v[40:43]
    v_mfma_f32_16x16x32_bf16 v[44:47], v[188:191], a[8:11], v[44:47]
    ds_read_b64_tr_b16 a[208:209], v16
    v_mfma_f32_16x16x32_bf16 v[32:35], v[192:195], a[12:15], v[32:35]
    buffer_load_dwordx4 a[60:63], v26, s[36:39], s79 offen offset:2048 sc1
    ds_read_b64_tr_b16 a[210:211], v16 offset:1024
    v_mfma_f32_16x16x32_bf16 v[36:39], v[196:199], a[12:15], v[36:39]
    ds_read_b64_tr_b16 a[212:213], v17
    v_mfma_f32_16x16x32_bf16 v[40:43], v[200:203], a[12:15], v[40:43]
    ds_read_b64_tr_b16 a[214:215], v17 offset:1024
    v_mfma_f32_16x16x32_bf16 v[44:47], v[204:207], a[12:15], v[44:47]
    ds_read_b64_tr_b16 a[216:217], v18
    v_mfma_f32_16x16x32_bf16 v[32:35], v[208:211], a[16:19], v[32:35]
    buffer_load_dwordx4 a[64:67], v26, s[36:39], s80 offen sc1
    ds_read_b64_tr_b16 a[218:219], v18 offset:1024
    v_mfma_f32_16x16x32_bf16 v[36:39], v[212:215], a[16:19], v[36:39]
    ds_read_b64_tr_b16 a[220:221], v19
    v_mfma_f32_16x16x32_bf16 v[40:43], v[216:219], a[16:19], v[40:43]
    ds_read_b64_tr_b16 a[222:223], v19 offset:1024
    v_mfma_f32_16x16x32_bf16 v[44:47], v[220:223], a[16:19], v[44:47]
    v_mfma_f32_16x16x32_bf16 v[32:35], v[224:227], a[20:23], v[32:35]
    buffer_load_dwordx4 a[68:71], v26, s[36:39], s80 offen offset:2048 sc1
    v_and_b32 v64, 15, v1
    v_mfma_f32_16x16x32_bf16 v[36:39], v[228:231], a[20:23], v[36:39]
    v_lshrrev_b32 v66, 4, v1
    v_mfma_f32_16x16x32_bf16 v[40:43], v[232:235], a[20:23], v[40:43]
    v_mul_u32_u24 v67, 896, v66
    v_mfma_f32_16x16x32_bf16 v[44:47], v[236:239], a[20:23], v[44:47]
    v_lshl_add_u32 v67, v64, 3, v67
    s_waitcnt vmcnt(12)
    v_mfma_f32_16x16x32_bf16 v[32:35], v[240:243], a[24:27], v[32:35]
    buffer_load_dwordx4 a[72:75], v26, s[36:39], s81 offen sc1
    v_mfma_f32_16x16x32_bf16 v[36:39], v[244:247], a[24:27], v[36:39]
    v_and_b32 v68, 7, v1
    v_mfma_f32_16x16x32_bf16 v[40:43], v[248:251], a[24:27], v[40:43]
    v_xor_b32 v68, v68, v66
    v_mfma_f32_16x16x32_bf16 v[44:47], v[252:255], a[24:27], v[44:47]
    v_lshlrev_b32 v68, 4, v68
    s_waitcnt lgkmcnt(0)
    v_mfma_f32_16x16x32_bf16 v[32:35], a[112:115], a[28:31], v[32:35]
    buffer_load_dwordx4 a[76:79], v26, s[36:39], s81 offen offset:2048 sc1
    v_mfma_f32_16x16x32_bf16 v[36:39], a[116:119], a[28:31], v[36:39]
    v_lshl_add_u32 v66, s3, 2, v66
    v_mfma_f32_16x16x32_bf16 v[40:43], a[120:123], a[28:31], v[40:43]
    v_and_b32 v69, 7, v66
    v_mfma_f32_16x16x32_bf16 v[44:47], a[124:127], a[28:31], v[44:47]
    v_xor_b32 v69, v69, v64
    s_waitcnt vmcnt(11)
    v_mfma_f32_16x16x32_bf16 v[32:35], a[128:131], a[32:35], v[32:35]
    buffer_load_dwordx4 a[80:83], v26, s[36:39], s82 offen sc1
    v_mfma_f32_16x16x32_bf16 v[36:39], a[132:135], a[32:35], v[36:39]
    v_lshlrev_b32 v69, 4, v69
    v_mfma_f32_16x16x32_bf16 v[40:43], a[136:139], a[32:35], v[40:43]
    v_lshl_add_u32 v66, v66, 8, v69
    v_mfma_f32_16x16x32_bf16 v[44:47], a[140:143], a[32:35], v[44:47]
    v_lshl_add_u32 v64, v64, 8, v68
    v_mfma_f32_16x16x32_bf16 v[32:35], a[144:147], a[36:39], v[32:35]
    buffer_load_dwordx4 a[84:87], v26, s[36:39], s82 offen offset:2048 sc1
    v_mfma_f32_16x16x32_bf16 v[36:39], a[148:151], a[36:39], v[36:39]
    v_add_u32 v64, s53, v64
    v_mfma_f32_16x16x32_bf16 v[40:43], a[152:155], a[36:39], v[40:43]
    v_xor_b32 v65, 64, v64
    v_mfma_f32_16x16x32_bf16 v[44:47], a[156:159], a[36:39], v[44:47]
    s_waitcnt vmcnt(11)
    v_mfma_f32_16x16x32_bf16 v[32:35], a[160:163], a[40:43], v[32:35]
    buffer_load_dwordx4 a[88:91], v26, s[36:39], s83 offen sc1
    s_lshl_b32 s4, s44, 3
    v_mfma_f32_16x16x32_bf16 v[36:39], a[164:167], a[40:43], v[36:39]
    s_add_u32 s4, s4, s45
    v_mfma_f32_16x16x32_bf16 v[40:43], a[168:171], a[40:43], v[40:43]
    s_lshl_b32 s4, s4, 2
    v_mfma_f32_16x16x32_bf16 v[44:47], a[172:175], a[40:43], v[44:47]
    s_add_u32 s4, s4, s3
    v_mfma_f32_16x16x32_bf16 v[32:35], a[176:179], a[44:47], v[32:35]
    buffer_load_dwordx4 a[92:95], v26, s[36:39], s83 offen offset:2048 sc1
    v_mfma_f32_16x16x32_bf16 v[36:39], a[180:183], a[44:47], v[36:39]
    s_mul_i32 s95, s4, 3584
    v_mfma_f32_16x16x32_bf16 v[40:43], a[184:187], a[44:47], v[40:43]
    s_lshl_b32 s4, s47, 7
    v_mfma_f32_16x16x32_bf16 v[44:47], a[188:191], a[44:47], v[44:47]
    s_add_u32 s95, s95, s4
    s_waitcnt vmcnt(10)
    v_mfma_f32_16x16x32_bf16 v[32:35], a[192:195], a[48:51], v[32:35]
    buffer_load_dwordx4 a[96:99], v26, s[36:39], s84 offen sc1
    s_barrier
    v_mfma_f32_16x16x32_bf16 v[36:39], a[196:199], a[48:51], v[36:39]
    v_mfma_f32_16x16x32_bf16 v[40:43], a[200:203], a[48:51], v[40:43]
    v_mfma_f32_16x16x32_bf16 v[44:47], a[204:207], a[48:51], v[44:47]
    v_mfma_f32_16x16x32_bf16 v[32:35], a[208:211], a[52:55], v[32:35]
    buffer_load_dwordx4 a[100:103], v26, s[36:39], s84 offen offset:2048 sc1
    v_mfma_f32_16x16x32_bf16 v[36:39], a[212:215], a[52:55], v[36:39]
    v_mfma_f32_16x16x32_bf16 v[40:43], a[216:219], a[52:55], v[40:43]
    v_mfma_f32_16x16x32_bf16 v[44:47], a[220:223], a[52:55], v[44:47]
    s_waitcnt vmcnt(10)
    v_mfma_f32_16x16x32_bf16 v[48:51], a[224:227], a[56:59], 0
    buffer_load_dwordx4 a[104:107], v26, s[36:39], s85 offen sc1
    v_mfma_f32_16x16x32_bf16 v[52:55], a[228:231], a[56:59], 0
    v_mfma_f32_16x16x32_bf16 v[56:59], a[232:235], a[56:59], 0
    v_mfma_f32_16x16x32_bf16 v[60:63], a[236:239], a[56:59], 0
    v_mfma_f32_16x16x32_bf16 v[48:51], a[240:243], a[60:63], v[48:51]
    buffer_load_dwordx4 a[108:111], v26, s[36:39], s85 offen offset:2048 sc1
    v_mfma_f32_16x16x32_bf16 v[52:55], a[244:247], a[60:63], v[52:55]
    v_mfma_f32_16x16x32_bf16 v[56:59], a[248:251], a[60:63], v[56:59]
    v_mfma_f32_16x16x32_bf16 v[60:63], a[252:255], a[60:63], v[60:63]
    s_waitcnt vmcnt(10)
    v_mfma_f32_16x16x32_bf16 v[48:51], v[176:179], a[64:67], v[48:51]
    ds_write_b128 v64, v[32:35]
    v_mfma_f32_16x16x32_bf16 v[52:55], v[180:183], a[64:67], v[52:55]
    v_mfma_f32_16x16x32_bf16 v[56:59], v[184:187], a[64:67], v[56:59]
    v_mfma_f32_16x16x32_bf16 v[60:63], v[188:191], a[64:67], v[60:63]
    v_add_u32 v26, 114688, v26
    v_mfma_f32_16x16x32_bf16 v[48:51], v[192:195], a[68:71], v[48:51]
    buffer_load_dwordx4 a[0:3], v26, s[36:39], s79 offen sc1
    v_mfma_f32_16x16x32_bf16 v[52:55], v[196:199], a[68:71], v[52:55]
    ds_write_b128 v65, v[36:39]
    v_mfma_f32_16x16x32_bf16 v[56:59], v[200:203], a[68:71], v[56:59]
    v_mfma_f32_16x16x32_bf16 v[60:63], v[204:207], a[68:71], v[60:63]
    s_waitcnt vmcnt(9)
    v_mfma_f32_16x16x32_bf16 v[48:51], v[208:211], a[72:75], v[48:51]
    buffer_load_dwordx4 a[4:7], v26, s[36:39], s79 offen offset:2048 sc1
    v_mfma_f32_16x16x32_bf16 v[52:55], v[212:215], a[72:75], v[52:55]
    ds_write_b128 v64, v[40:43] offset:128
    v_mfma_f32_16x16x32_bf16 v[56:59], v[216:219], a[72:75], v[56:59]
    v_mfma_f32_16x16x32_bf16 v[60:63], v[220:223], a[72:75], v[60:63]
    v_mfma_f32_16x16x32_bf16 v[48:51], v[224:227], a[76:79], v[48:51]
    buffer_load_dwordx4 a[8:11], v26, s[36:39], s80 offen sc1
    v_mfma_f32_16x16x32_bf16 v[52:55], v[228:231], a[76:79], v[52:55]
    v_mfma_f32_16x16x32_bf16 v[56:59], v[232:235], a[76:79], v[56:59]
    ds_write_b128 v65, v[44:47] offset:128
    v_mfma_f32_16x16x32_bf16 v[60:63], v[236:239], a[76:79], v[60:63]
    s_waitcnt vmcnt(9)
    v_mfma_f32_16x16x32_bf16 v[48:51], v[240:243], a[80:83], v[48:51]
    buffer_load_dwordx4 a[12:15], v26, s[36:39], s80 offen offset:2048 sc1
    v_mfma_f32_16x16x32_bf16 v[52:55], v[244:247], a[80:83], v[52:55]
    v_mfma_f32_16x16x32_bf16 v[56:59], v[248:251], a[80:83], v[56:59]
    v_lshlrev_b32 v68, 16, v168
    v_and_b32 v69, 0xffff0000, v168
    v_mfma_f32_16x16x32_bf16 v[60:63], v[252:255], a[80:83], v[60:63]
    v_lshlrev_b32 v70, 16, v169
    v_and_b32 v71, 0xffff0000, v169
    v_mfma_f32_16x16x32_bf16 v[48:51], a[112:115], a[84:87], v[48:51]
    buffer_load_dwordx4 a[16:19], v26, s[36:39], s81 offen sc1
    s_add_u32 s5, s95, 0
    v_mfma_f32_16x16x32_bf16 v[52:55], a[116:119], a[84:87], v[52:55]
    v_mfma_f32_16x16x32_bf16 v[56:59], a[120:123], a[84:87], v[56:59]
    v_mfma_f32_16x16x32_bf16 v[60:63], a[124:127], a[84:87], v[60:63]
    s_waitcnt lgkmcnt(0)
    s_barrier
    ds_read_b128 v[72:75], v66
    s_waitcnt vmcnt(9)
    v_mfma_f32_16x16x32_bf16 v[48:51], a[128:131], a[88:91], v[48:51]
    buffer_load_dwordx4 a[20:23], v26, s[36:39], s81 offen offset:2048 sc1
    ds_read_b128 v[76:79], v66 offset:4096
    ds_read_b128 v[80:83], v66 offset:8192
    v_mfma_f32_16x16x32_bf16 v[52:55], a[132:135], a[88:91], v[52:55]
    ds_read_b128 v[84:87], v66 offset:12288
    v_mfma_f32_16x16x32_bf16 v[56:59], a[136:139], a[88:91], v[56:59]
    v_mfma_f32_16x16x32_bf16 v[60:63], a[140:143], a[88:91], v[60:63]
    v_mfma_f32_16x16x32_bf16 v[48:51], a[144:147], a[92:95], v[48:51]
    buffer_load_dwordx4 a[24:27], v26, s[36:39], s82 offen sc1
    v_mfma_f32_16x16x32_bf16 v[52:55], a[148:151], a[92:95], v[52:55]
    v_mfma_f32_16x16x32_bf16 v[56:59], a[152:155], a[92:95], v[56:59]
    v_mfma_f32_16x16x32_bf16 v[60:63], a[156:159], a[92:95], v[60:63]
    s_waitcnt vmcnt(9)
    v_mfma_f32_16x16x32_bf16 v[48:51], a[160:163], a[96:99], v[48:51]
    buffer_load_dwordx4 a[28:31], v26, s[36:39], s82 offen offset:2048 sc1
    v_mfma_f32_16x16x32_bf16 v[52:55], a[164:167], a[96:99], v[52:55]
    s_waitcnt lgkmcnt(0)
    v_add_f32 v68, v68, v72
    v_add_f32 v69, v69, v73
    v_mfma_f32_16x16x32_bf16 v[56:59], a[168:171], a[96:99], v[56:59]
    v_add_f32 v70, v70, v74
    v_add_f32 v71, v71, v75
    v_mfma_f32_16x16x32_bf16 v[60:63], a[172:175], a[96:99], v[60:63]
    v_add_f32 v68, v68, v76
    v_add_f32 v69, v69, v77
    v_mfma_f32_16x16x32_bf16 v[48:51], a[176:179], a[100:103], v[48:51]
    buffer_load_dwordx4 a[32:35], v26, s[36:39], s83 offen sc1
    v_add_f32 v70, v70, v78
    v_mfma_f32_16x16x32_bf16 v[52:55], a[180:183], a[100:103], v[52:55]
    v_add_f32 v71, v71, v79
    v_add_f32 v68, v68, v80
    v_mfma_f32_16x16x32_bf16 v[56:59], a[184:187], a[100:103], v[56:59]
    v_add_f32 v69, v69, v81
    v_add_f32 v70, v70, v82
    v_mfma_f32_16x16x32_bf16 v[60:63], a[188:191], a[100:103], v[60:63]
    v_add_f32 v71, v71, v83
    s_waitcnt vmcnt(9)
    v_mfma_f32_16x16x32_bf16 v[48:51], a[192:195], a[104:107], v[48:51]
    buffer_load_dwordx4 a[36:39], v26, s[36:39], s83 offen offset:2048 sc1
    v_add_f32 v68, v68, v84
    v_mfma_f32_16x16x32_bf16 v[52:55], a[196:199], a[104:107], v[52:55]
    v_add_f32 v69, v69, v85
    v_add_f32 v70, v70, v86
    v_add_f32 v71, v71, v87
    v_cvt_pk_bf16_f32 v68, v68, v69
    v_cvt_pk_bf16_f32 v69, v70, v71
    buffer_store_dwordx2 v[68:69], v67, s[32:35], s5 offen sc1
    v_mfma_f32_16x16x32_bf16 v[56:59], a[200:203], a[104:107], v[56:59]
    v_mfma_f32_16x16x32_bf16 v[60:63], a[204:207], a[104:107], v[60:63]
    v_mfma_f32_16x16x32_bf16 v[48:51], a[208:211], a[108:111], v[48:51]
    buffer_load_dwordx4 a[40:43], v26, s[36:39], s84 offen sc1
    v_mfma_f32_16x16x32_bf16 v[52:55], a[212:215], a[108:111], v[52:55]
    v_mfma_f32_16x16x32_bf16 v[56:59], a[216:219], a[108:111], v[56:59]
    v_mfma_f32_16x16x32_bf16 v[60:63], a[220:223], a[108:111], v[60:63]
    s_waitcnt vmcnt(10)
    v_mfma_f32_16x16x32_bf16 v[32:35], a[224:227], a[0:3], 0
    buffer_load_dwordx4 a[44:47], v26, s[36:39], s84 offen offset:2048 sc1
    v_mfma_f32_16x16x32_bf16 v[36:39], a[228:231], a[0:3], 0
    v_mfma_f32_16x16x32_bf16 v[40:43], a[232:235], a[0:3], 0
    v_mfma_f32_16x16x32_bf16 v[44:47], a[236:239], a[0:3], 0
    v_mfma_f32_16x16x32_bf16 v[32:35], a[240:243], a[4:7], v[32:35]
    buffer_load_dwordx4 a[48:51], v26, s[36:39], s85 offen sc1
    v_mfma_f32_16x16x32_bf16 v[36:39], a[244:247], a[4:7], v[36:39]
    v_mfma_f32_16x16x32_bf16 v[40:43], a[248:251], a[4:7], v[40:43]
    v_mfma_f32_16x16x32_bf16 v[44:47], a[252:255], a[4:7], v[44:47]
    s_waitcnt vmcnt(10)
    v_mfma_f32_16x16x32_bf16 v[32:35], v[176:179], a[8:11], v[32:35]
    buffer_load_dwordx4 a[52:55], v26, s[36:39], s85 offen offset:2048 sc1
    ds_write_b128 v64, v[48:51] offset:16384
    v_mfma_f32_16x16x32_bf16 v[36:39], v[180:183], a[8:11], v[36:39]
    v_mfma_f32_16x16x32_bf16 v[40:43], v[184:187], a[8:11], v[40:43]
    v_mfma_f32_16x16x32_bf16 v[44:47], v[188:191], a[8:11], v[44:47]
    v_add_u32 v26, 114688, v26
    v_mfma_f32_16x16x32_bf16 v[32:35], v[192:195], a[12:15], v[32:35]
    buffer_load_dwordx4 a[56:59], v26, s[36:39], s79 offen sc1
    v_mfma_f32_16x16x32_bf16 v[36:39], v[196:199], a[12:15], v[36:39]
    ds_write_b128 v65, v[52:55] offset:16384
    v_mfma_f32_16x16x32_bf16 v[40:43], v[200:203], a[12:15], v[40:43]
    v_mfma_f32_16x16x32_bf16 v[44:47], v[204:207], a[12:15], v[44:47]
    s_waitcnt vmcnt(10)
    v_mfma_f32_16x16x32_bf16 v[32:35], v[208:211], a[16:19], v[32:35]
    buffer_load_dwordx4 a[60:63], v26, s[36:39], s79 offen offset:2048 sc1
    v_mfma_f32_16x16x32_bf16 v[36:39], v[212:215], a[16:19], v[36:39]
    ds_write_b128 v64, v[56:59] offset:16512
    v_mfma_f32_16x16x32_bf16 v[40:43], v[216:219], a[16:19], v[40:43]
    v_mfma_f32_16x16x32_bf16 v[44:47], v[220:223], a[16:19], v[44:47]
    v_mfma_f32_16x16x32_bf16 v[32:35], v[224:227], a[20:23], v[32:35]
    buffer_load_dwordx4 a[64:67], v26, s[36:39], s80 offen sc1
    v_mfma_f32_16x16x32_bf16 v[36:39], v[228:231], a[20:23], v[36:39]
    v_mfma_f32_16x16x32_bf16 v[40:43], v[232:235], a[20:23], v[40:43]
    ds_write_b128 v65, v[60:63] offset:16512
    v_mfma_f32_16x16x32_bf16 v[44:47], v[236:239], a[20:23], v[44:47]
    s_waitcnt vmcnt(10)
    v_mfma_f32_16x16x32_bf16 v[32:35], v[240:243], a[24:27], v[32:35]
    buffer_load_dwordx4 a[68:71], v26, s[36:39], s80 offen offset:2048 sc1
    v_mfma_f32_16x16x32_bf16 v[36:39], v[244:247], a[24:27], v[36:39]
    v_mfma_f32_16x16x32_bf16 v[40:43], v[248:251], a[24:27], v[40:43]
    v_lshlrev_b32 v68, 16, v170
    v_and_b32 v69, 0xffff0000, v170
    v_mfma_f32_16x16x32_bf16 v[44:47], v[252:255], a[24:27], v[44:47]
    v_lshlrev_b32 v70, 16, v171
    v_and_b32 v71, 0xffff0000, v171
    v_mfma_f32_16x16x32_bf16 v[32:35], a[112:115], a[28:31], v[32:35]
    buffer_load_dwordx4 a[72:75], v26, s[36:39], s81 offen sc1
    s_add_u32 s5, s95, 28672
    v_mfma_f32_16x16x32_bf16 v[36:39], a[116:119], a[28:31], v[36:39]
    v_mfma_f32_16x16x32_bf16 v[40:43], a[120:123], a[28:31], v[40:43]
    v_mfma_f32_16x16x32_bf16 v[44:47], a[124:127], a[28:31], v[44:47]
    s_waitcnt lgkmcnt(0)
    s_barrier
    ds_read_b128 v[72:75], v66 offset:16384
    s_waitcnt vmcnt(10)
    v_mfma_f32_16x16x32_bf16 v[32:35], a[128:131], a[32:35], v[32:35]
    buffer_load_dwordx4 a[76:79], v26, s[36:39], s81 offen offset:2048 sc1
    ds_read_b128 v[76:79], v66 offset:20480
    ds_read_b128 v[80:83], v66 offset:24576
    v_mfma_f32_16x16x32_bf16 v[36:39], a[132:135], a[32:35], v[36:39]
    ds_read_b128 v[84:87], v66 offset:28672
    v_mfma_f32_16x16x32_bf16 v[40:43], a[136:139], a[32:35], v[40:43]
    v_mfma_f32_16x16x32_bf16 v[44:47], a[140:143], a[32:35], v[44:47]
    v_mfma_f32_16x16x32_bf16 v[32:35], a[144:147], a[36:39], v[32:35]
    buffer_load_dwordx4 a[80:83], v26, s[36:39], s82 offen sc1
    v_mfma_f32_16x16x32_bf16 v[36:39], a[148:151], a[36:39], v[36:39]
    v_mfma_f32_16x16x32_bf16 v[40:43], a[152:155], a[36:39], v[40:43]
    v_mfma_f32_16x16x32_bf16 v[44:47], a[156:159], a[36:39], v[44:47]
    s_waitcnt vmcnt(9)
    v_mfma_f32_16x16x32_bf16 v[32:35], a[160:163], a[40:43], v[32:35]
    buffer_load_dwordx4 a[84:87], v26, s[36:39], s82 offen offset:2048 sc1
    v_mfma_f32_16x16x32_bf16 v[36:39], a[164:167], a[40:43], v[36:39]
    s_waitcnt lgkmcnt(0)
    v_add_f32 v68, v68, v72
    v_add_f32 v69, v69, v73
    v_mfma_f32_16x16x32_bf16 v[40:43], a[168:171], a[40:43], v[40:43]
    v_add_f32 v70, v70, v74
    v_add_f32 v71, v71, v75
    v_mfma_f32_16x16x32_bf16 v[44:47], a[172:175], a[40:43], v[44:47]
    v_add_f32 v68, v68, v76
    v_add_f32 v69, v69, v77
    v_mfma_f32_16x16x32_bf16 v[32:35], a[176:179], a[44:47], v[32:35]
    buffer_load_dwordx4 a[88:91], v26, s[36:39], s83 offen sc1
    v_add_f32 v70, v70, v78
    v_mfma_f32_16x16x32_bf16 v[36:39], a[180:183], a[44:47], v[36:39]
    v_add_f32 v71, v71, v79
    v_add_f32 v68, v68, v80
    v_mfma_f32_16x16x32_bf16 v[40:43], a[184:187], a[44:47], v[40:43]
    v_add_f32 v69, v69, v81
    v_add_f32 v70, v70, v82
    v_mfma_f32_16x16x32_bf16 v[44:47], a[188:191], a[44:47], v[44:47]
    v_add_f32 v71, v71, v83
    s_waitcnt vmcnt(9)
    v_mfma_f32_16x16x32_bf16 v[32:35], a[192:195], a[48:51], v[32:35]
    buffer_load_dwordx4 a[92:95], v26, s[36:39], s83 offen offset:2048 sc1
    v_add_f32 v68, v68, v84
    v_mfma_f32_16x16x32_bf16 v[36:39], a[196:199], a[48:51], v[36:39]
    v_add_f32 v69, v69, v85
    v_add_f32 v70, v70, v86
    v_add_f32 v71, v71, v87
    v_cvt_pk_bf16_f32 v68, v68, v69
    v_cvt_pk_bf16_f32 v69, v70, v71
    buffer_store_dwordx2 v[68:69], v67, s[32:35], s5 offen sc1
    v_mfma_f32_16x16x32_bf16 v[40:43], a[200:203], a[48:51], v[40:43]
    v_mfma_f32_16x16x32_bf16 v[44:47], a[204:207], a[48:51], v[44:47]
    v_mfma_f32_16x16x32_bf16 v[32:35], a[208:211], a[52:55], v[32:35]
    buffer_load_dwordx4 a[96:99], v26, s[36:39], s84 offen sc1
    v_mfma_f32_16x16x32_bf16 v[36:39], a[212:215], a[52:55], v[36:39]
    v_mfma_f32_16x16x32_bf16 v[40:43], a[216:219], a[52:55], v[40:43]
    v_mfma_f32_16x16x32_bf16 v[44:47], a[220:223], a[52:55], v[44:47]
    s_waitcnt vmcnt(10)
    v_mfma_f32_16x16x32_bf16 v[48:51], a[224:227], a[56:59], 0
    buffer_load_dwordx4 a[100:103], v26, s[36:39], s84 offen offset:2048 sc1
    v_mfma_f32_16x16x32_bf16 v[52:55], a[228:231], a[56:59], 0
    v_mfma_f32_16x16x32_bf16 v[56:59], a[232:235], a[56:59], 0
    v_mfma_f32_16x16x32_bf16 v[60:63], a[236:239], a[56:59], 0
    v_cmp_u_f32 vcc, v32, v32
    s_cbranch_vccnz L_nn_87
L_nb_88:
    v_mfma_f32_16x16x32_bf16 v[48:51], a[240:243], a[60:63], v[48:51]
    buffer_load_dwordx4 a[104:107], v26, s[36:39], s85 offen sc1
    v_mfma_f32_16x16x32_bf16 v[52:55], a[244:247], a[60:63], v[52:55]
    v_mfma_f32_16x16x32_bf16 v[56:59], a[248:251], a[60:63], v[56:59]
    v_mfma_f32_16x16x32_bf16 v[60:63], a[252:255], a[60:63], v[60:63]
    s_waitcnt vmcnt(10)
    v_mfma_f32_16x16x32_bf16 v[48:51], v[176:179], a[64:67], v[48:51]
    buffer_load_dwordx4 a[108:111], v26, s[36:39], s85 offen offset:2048 sc1
    ds_write_b128 v64, v[32:35]
    v_mfma_f32_16x16x32_bf16 v[52:55], v[180:183], a[64:67], v[52:55]
    v_mfma_f32_16x16x32_bf16 v[56:59], v[184:187], a[64:67], v[56:59]
    v_mfma_f32_16x16x32_bf16 v[60:63], v[188:191], a[64:67], v[60:63]
    v_mfma_f32_16x16x32_bf16 v[48:51], v[192:195], a[68:71], v[48:51]
    v_mfma_f32_16x16x32_bf16 v[52:55], v[196:199], a[68:71], v[52:55]
    ds_write_b128 v65, v[36:39]
    v_mfma_f32_16x16x32_bf16 v[56:59], v[200:203], a[68:71], v[56:59]
    v_mfma_f32_16x16x32_bf16 v[60:63], v[204:207], a[68:71], v[60:63]
    s_waitcnt vmcnt(9)
    v_mfma_f32_16x16x32_bf16 v[48:51], v[208:211], a[72:75], v[48:51]
    v_mfma_f32_16x16x32_bf16 v[52:55], v[212:215], a[72:75], v[52:55]
    ds_write_b128 v64, v[40:43] offset:128
    v_mfma_f32_16x16x32_bf16 v[56:59], v[216:219], a[72:75], v[56:59]
    v_mfma_f32_16x16x32_bf16 v[60:63], v[220:223], a[72:75], v[60:63]
    v_mfma_f32_16x16x32_bf16 v[48:51], v[224:227], a[76:79], v[48:51]
    v_mfma_f32_16x16x32_bf16 v[52:55], v[228:231], a[76:79], v[52:55]
    v_mfma_f32_16x16x32_bf16 v[56:59], v[232:235], a[76:79], v[56:59]
    ds_write_b128 v65, v[44:47] offset:128
    v_mfma_f32_16x16x32_bf16 v[60:63], v[236:239], a[76:79], v[60:63]
    s_waitcnt vmcnt(7)
    v_mfma_f32_16x16x32_bf16 v[48:51], v[240:243], a[80:83], v[48:51]
    v_mfma_f32_16x16x32_bf16 v[52:55], v[244:247], a[80:83], v[52:55]
    v_mfma_f32_16x16x32_bf16 v[56:59], v[248:251], a[80:83], v[56:59]
    v_lshlrev_b32 v68, 16, v172
    v_and_b32 v69, 0xffff0000, v172
    v_mfma_f32_16x16x32_bf16 v[60:63], v[252:255], a[80:83], v[60:63]
    v_lshlrev_b32 v70, 16, v173
    v_and_b32 v71, 0xffff0000, v173
    v_mfma_f32_16x16x32_bf16 v[48:51], a[112:115], a[84:87], v[48:51]
    s_add_u32 s5, s95, 57344
    v_mfma_f32_16x16x32_bf16 v[52:55], a[116:119], a[84:87], v[52:55]
    v_mfma_f32_16x16x32_bf16 v[56:59], a[120:123], a[84:87], v[56:59]
    v_mfma_f32_16x16x32_bf16 v[60:63], a[124:127], a[84:87], v[60:63]
    s_waitcnt lgkmcnt(0)
    s_barrier
    ds_read_b128 v[72:75], v66
    s_waitcnt vmcnt(5)
    v_mfma_f32_16x16x32_bf16 v[48:51], a[128:131], a[88:91], v[48:51]
    ds_read_b128 v[76:79], v66 offset:4096
    ds_read_b128 v[80:83], v66 offset:8192
    v_mfma_f32_16x16x32_bf16 v[52:55], a[132:135], a[88:91], v[52:55]
    ds_read_b128 v[84:87], v66 offset:12288
    v_mfma_f32_16x16x32_bf16 v[56:59], a[136:139], a[88:91], v[56:59]
    v_mfma_f32_16x16x32_bf16 v[60:63], a[140:143], a[88:91], v[60:63]
    v_mfma_f32_16x16x32_bf16 v[48:51], a[144:147], a[92:95], v[48:51]
    v_mfma_f32_16x16x32_bf16 v[52:55], a[148:151], a[92:95], v[52:55]
    v_mfma_f32_16x16x32_bf16 v[56:59], a[152:155], a[92:95], v[56:59]
    v_mfma_f32_16x16x32_bf16 v[60:63], a[156:159], a[92:95], v[60:63]
    s_waitcnt vmcnt(2)
    v_mfma_f32_16x16x32_bf16 v[48:51], a[160:163], a[96:99], v[48:51]
    v_mfma_f32_16x16x32_bf16 v[52:55], a[164:167], a[96:99], v[52:55]
    s_waitcnt lgkmcnt(0)
    v_add_f32 v68, v68, v72
    v_add_f32 v69, v69, v73
    v_mfma_f32_16x16x32_bf16 v[56:59], a[168:171], a[96:99], v[56:59]
    v_add_f32 v70, v70, v74
    v_add_f32 v71, v71, v75
    v_mfma_f32_16x16x32_bf16 v[60:63], a[172:175], a[96:99], v[60:63]
    v_add_f32 v68, v68, v76
    v_add_f32 v69, v69, v77
    v_mfma_f32_16x16x32_bf16 v[48:51], a[176:179], a[100:103], v[48:51]
    v_add_f32 v70, v70, v78
    v_add_f32 v71, v71, v79
    v_mfma_f32_16x16x32_bf16 v[52:55], a[180:183], a[100:103], v[52:55]
    v_add_f32 v68, v68, v80
    v_add_f32 v69, v69, v81
    v_mfma_f32_16x16x32_bf16 v[56:59], a[184:187], a[100:103], v[56:59]
    v_add_f32 v70, v70, v82
    v_add_f32 v71, v71, v83
    v_mfma_f32_16x16x32_bf16 v[60:63], a[188:191], a[100:103], v[60:63]
    v_add_f32 v68, v68, v84
    s_waitcnt vmcnt(0)
    v_mfma_f32_16x16x32_bf16 v[48:51], a[192:195], a[104:107], v[48:51]
    v_add_f32 v69, v69, v85
    v_add_f32 v70, v70, v86
    v_mfma_f32_16x16x32_bf16 v[52:55], a[196:199], a[104:107], v[52:55]
    v_add_f32 v71, v71, v87
    v_cvt_pk_bf16_f32 v68, v68, v69
    v_cvt_pk_bf16_f32 v69, v70, v71
    buffer_store_dwordx2 v[68:69], v67, s[32:35], s5 offen sc1
    v_mfma_f32_16x16x32_bf16 v[56:59], a[200:203], a[104:107], v[56:59]
    v_mfma_f32_16x16x32_bf16 v[60:63], a[204:207], a[104:107], v[60:63]
    v_mfma_f32_16x16x32_bf16 v[48:51], a[208:211], a[108:111], v[48:51]
    v_mfma_f32_16x16x32_bf16 v[52:55], a[212:215], a[108:111], v[52:55]
    v_mfma_f32_16x16x32_bf16 v[56:59], a[216:219], a[108:111], v[56:59]
    v_mfma_f32_16x16x32_bf16 v[60:63], a[220:223], a[108:111], v[60:63]
    s_nop 4
    v_cmp_u_f32 vcc, v48, v48
    s_cbranch_vccnz L_nn_89
L_nb_90:
    s_nop 2
    ds_write_b128 v64, v[48:51] offset:16384
    ds_write_b128 v65, v[52:55] offset:16384
    ds_write_b128 v64, v[56:59] offset:16512
    ds_write_b128 v65, v[60:63] offset:16512
    v_lshlrev_b32 v68, 16, v174
    v_and_b32 v69, 0xffff0000, v174
    v_lshlrev_b32 v70, 16, v175
    v_and_b32 v71, 0xffff0000, v175
    s_add_u32 s5, s95, 86016
    s_waitcnt lgkmcnt(0)
    s_barrier
    ds_read_b128 v[72:75], v66 offset:16384
    ds_read_b128 v[76:79], v66 offset:20480
    ds_read_b128 v[80:83], v66 offset:24576
    ds_read_b128 v[84:87], v66 offset:28672
    s_waitcnt lgkmcnt(3)
    v_pk_add_f32 v[68:69], v[68:69], v[72:73]
    v_pk_add_f32 v[70:71], v[70:71], v[74:75]
    s_waitcnt lgkmcnt(2)
    v_pk_add_f32 v[68:69], v[68:69], v[76:77]
    v_pk_add_f32 v[70:71], v[70:71], v[78:79]
    s_waitcnt lgkmcnt(1)
    v_pk_add_f32 v[68:69], v[68:69], v[80:81]
    v_pk_add_f32 v[70:71], v[70:71], v[82:83]
    s_waitcnt lgkmcnt(0)
    v_pk_add_f32 v[68:69], v[68:69], v[84:85]
    v_pk_add_f32 v[70:71], v[70:71], v[86:87]
    v_cvt_pk_bf16_f32 v68, v68, v69
    v_cvt_pk_bf16_f32 v69, v70, v71
    buffer_store_dwordx2 v[68:69], v67, s[32:35], s5 offen sc1
L_fin:
    s_waitcnt vmcnt(0) lgkmcnt(0)
    s_endpgm
L_helper:
    s_lshl3_add_u32 s88, s44, s45
    s_lshl2_add_u32 s88, s88, s3
    s_mul_i32 s88, s88, 14336
    s_add_u32 s88, s88, 6520832
    s_lshl1_add_u32 s89, s44, s45
    s_lshl_b32 s89, s89, 7
    s_add_u32 s89, s89, 692224
    v_mov_b32 v152, s40
    v_mov_b32 v153, s40
    v_mov_b32 v154, s40
    v_mov_b32 v155, s40
    s_cmp_ge_u32 s44, 14
    s_cbranch_scc1 L_help2
    s_mul_i32 s5, s45, 14
    s_add_u32 s5, s5, s44
    s_lshl_b32 s6, s5, 7
    s_add_u32 s7, s6, 1024
    s_cmp_ge_u32 s3, 2
    s_cselect_b64 s[12:13], s[24:25], s[20:21]
    s_cselect_b32 s14, s26, s22
    s_cselect_b32 s6, s7, s6
    s_cselect_b32 s7, 28, 0
    s_add_u32 s5, s5, s7
    s_mul_i32 s7, s87, 802816
    s_add_u32 s6, s6, s7
    v_lshrrev_b32 v20, 3, v1
    v_and_b32 v21, 7, v1
    v_lshl_add_u32 v22, v21, 3, v20
    v_lshlrev_b32 v22, 3, v22
    v_mul_u32_u24 v20, 3584, v20
    v_lshl_add_u32 v20, v21, 4, v20
    v_mov_b32 v144, 0
    v_mov_b32 v145, 0
    v_mov_b32 v146, 0
    v_mov_b32 v147, 0
    v_mov_b32 v148, 0
    v_mov_b32 v149, 0
    v_mov_b32 v150, 0
    v_mov_b32 v151, 0
    buffer_load_dwordx4 v[32:35], v20, s[12:15], s6 offen
    s_add_u32 s6, s6, 28672
    buffer_load_dwordx4 v[36:39], v20, s[12:15], s6 offen
    s_add_u32 s6, s6, 28672
    buffer_load_dwordx4 v[40:43], v20, s[12:15], s6 offen
    s_add_u32 s6, s6, 28672
    buffer_load_dwordx4 v[44:47], v20, s[12:15], s6 offen
    s_add_u32 s6, s6, 28672
    buffer_load_dwordx4 v[48:51], v20, s[12:15], s6 offen
    s_add_u32 s6, s6, 28672
    buffer_load_dwordx4 v[52:55], v20, s[12:15], s6 offen
    s_add_u32 s6, s6, 28672
    buffer_load_dwordx4 v[56:59], v20, s[12:15], s6 offen
    s_add_u32 s6, s6, 28672
    buffer_load_dwordx4 v[60:63], v20, s[12:15], s6 offen
    s_add_u32 s6, s6, 28672
    buffer_load_dwordx4 v[64:67], v20, s[12:15], s6 offen
    s_add_u32 s6, s6, 28672
    buffer_load_dwordx4 v[68:71], v20, s[12:15], s6 offen
    s_add_u32 s6, s6, 28672
    buffer_load_dwordx4 v[72:75], v20, s[12:15], s6 offen
    s_add_u32 s6, s6, 28672
    buffer_load_dwordx4 v[76:79], v20, s[12:15], s6 offen
    s_add_u32 s6, s6, 28672
    buffer_load_dwordx4 v[80:83], v20, s[12:15], s6 offen
    s_add_u32 s6, s6, 28672
    s_waitcnt vmcnt(12)
    v_dot2c_f32_bf16 v144, s98, v32
    v_dot2c_f32_bf16 v145, s99, v32
    v_dot2c_f32_bf16 v146, s98, v33
    v_dot2c_f32_bf16 v147, s99, v33
    v_dot2c_f32_bf16 v148, s98, v34
    v_dot2c_f32_bf16 v149, s99, v34
    v_dot2c_f32_bf16 v150, s98, v35
    v_dot2c_f32_bf16 v151, s99, v35
    buffer_load_dwordx4 v[84:87], v20, s[12:15], s6 offen
    s_add_u32 s6, s6, 28672
    s_waitcnt vmcnt(12)
    v_dot2c_f32_bf16 v144, s98, v36
    v_dot2c_f32_bf16 v145, s99, v36
    v_dot2c_f32_bf16 v146, s98, v37
    v_dot2c_f32_bf16 v147, s99, v37
    v_dot2c_f32_bf16 v148, s98, v38
    v_dot2c_f32_bf16 v149, s99, v38
    v_dot2c_f32_bf16 v150, s98, v39
    v_dot2c_f32_bf16 v151, s99, v39
    buffer_load_dwordx4 v[88:91], v20, s[12:15], s6 offen
    s_add_u32 s6, s6, 28672
    s_waitcnt vmcnt(12)
    v_dot2c_f32_bf16 v144, s98, v40
    v_dot2c_f32_bf16 v145, s99, v40
    v_dot2c_f32_bf16 v146, s98, v41
    v_dot2c_f32_bf16 v147, s99, v41
    v_dot2c_f32_bf16 v148, s98, v42
    v_dot2c_f32_bf16 v149, s99, v42
    v_dot2c_f32_bf16 v150, s98, v43
    v_dot2c_f32_bf16 v151, s99, v43
    buffer_load_dwordx4 v[92:95], v20, s[12:15], s6 offen
    s_add_u32 s6, s6, 28672
    s_waitcnt vmcnt(12)
    v_dot2c_f32_bf16 v144, s98, v44
    v_dot2c_f32_bf16 v145, s99, v44
    v_dot2c_f32_bf16 v146, s98, v45
    v_dot2c_f32_bf16 v147, s99, v45
    v_dot2c_f32_bf16 v148, s98, v46
    v_dot2c_f32_bf16 v149, s99, v46
    v_dot2c_f32_bf16 v150, s98, v47
    v_dot2c_f32_bf16 v151, s99, v47
    buffer_load_dwordx4 v[96:99], v20, s[12:15], s6 offen
    s_add_u32 s6, s6, 28672
    s_waitcnt vmcnt(12)
    v_dot2c_f32_bf16 v144, s98, v48
    v_dot2c_f32_bf16 v145, s99, v48
    v_dot2c_f32_bf16 v146, s98, v49
    v_dot2c_f32_bf16 v147, s99, v49
    v_dot2c_f32_bf16 v148, s98, v50
    v_dot2c_f32_bf16 v149, s99, v50
    v_dot2c_f32_bf16 v150, s98, v51
    v_dot2c_f32_bf16 v151, s99, v51
    buffer_load_dwordx4 v[100:103], v20, s[12:15], s6 offen
    s_add_u32 s6, s6, 28672
    s_waitcnt vmcnt(12)
    v_dot2c_f32_bf16 v144, s98, v52
    v_dot2c_f32_bf16 v145, s99, v52
    v_dot2c_f32_bf16 v146, s98, v53
    v_dot2c_f32_bf16 v147, s99, v53
    v_dot2c_f32_bf16 v148, s98, v54
    v_dot2c_f32_bf16 v149, s99, v54
    v_dot2c_f32_bf16 v150, s98, v55
    v_dot2c_f32_bf16 v151, s99, v55
    buffer_load_dwordx4 v[104:107], v20, s[12:15], s6 offen
    s_add_u32 s6, s6, 28672
    s_waitcnt vmcnt(12)
    v_dot2c_f32_bf16 v144, s98, v56
    v_dot2c_f32_bf16 v145, s99, v56
    v_dot2c_f32_bf16 v146, s98, v57
    v_dot2c_f32_bf16 v147, s99, v57
    v_dot2c_f32_bf16 v148, s98, v58
    v_dot2c_f32_bf16 v149, s99, v58
    v_dot2c_f32_bf16 v150, s98, v59
    v_dot2c_f32_bf16 v151, s99, v59
    buffer_load_dwordx4 v[108:111], v20, s[12:15], s6 offen
    s_add_u32 s6, s6, 28672
    s_waitcnt vmcnt(12)
    v_dot2c_f32_bf16 v144, s98, v60
    v_dot2c_f32_bf16 v145, s99, v60
    v_dot2c_f32_bf16 v146, s98, v61
    v_dot2c_f32_bf16 v147, s99, v61
    v_dot2c_f32_bf16 v148, s98, v62
    v_dot2c_f32_bf16 v149, s99, v62
    v_dot2c_f32_bf16 v150, s98, v63
    v_dot2c_f32_bf16 v151, s99, v63
    buffer_load_dwordx4 v[112:115], v20, s[12:15], s6 offen
    s_add_u32 s6, s6, 28672
    s_waitcnt vmcnt(12)
    v_dot2c_f32_bf16 v144, s98, v64
    v_dot2c_f32_bf16 v145, s99, v64
    v_dot2c_f32_bf16 v146, s98, v65
    v_dot2c_f32_bf16 v147, s99, v65
    v_dot2c_f32_bf16 v148, s98, v66
    v_dot2c_f32_bf16 v149, s99, v66
    v_dot2c_f32_bf16 v150, s98, v67
    v_dot2c_f32_bf16 v151, s99, v67
    buffer_load_dwordx4 v[116:119], v20, s[12:15], s6 offen
    s_add_u32 s6, s6, 28672
    s_waitcnt vmcnt(12)
    v_dot2c_f32_bf16 v144, s98, v68
    v_dot2c_f32_bf16 v145, s99, v68
    v_dot2c_f32_bf16 v146, s98, v69
    v_dot2c_f32_bf16 v147, s99, v69
    v_dot2c_f32_bf16 v148, s98, v70
    v_dot2c_f32_bf16 v149, s99, v70
    v_dot2c_f32_bf16 v150, s98, v71
    v_dot2c_f32_bf16 v151, s99, v71
    buffer_load_dwordx4 v[120:123], v20, s[12:15], s6 offen
    s_add_u32 s6, s6, 28672
    s_waitcnt vmcnt(12)
    v_dot2c_f32_bf16 v144, s98, v72
    v_dot2c_f32_bf16 v145, s99, v72
    v_dot2c_f32_bf16 v146, s98, v73
    v_dot2c_f32_bf16 v147, s99, v73
    v_dot2c_f32_bf16 v148, s98, v74
    v_dot2c_f32_bf16 v149, s99, v74
    v_dot2c_f32_bf16 v150, s98, v75
    v_dot2c_f32_bf16 v151, s99, v75
    buffer_load_dwordx4 v[124:127], v20, s[12:15], s6 offen
    s_add_u32 s6, s6, 28672
    s_waitcnt vmcnt(12)
    v_dot2c_f32_bf16 v144, s98, v76
    v_dot2c_f32_bf16 v145, s99, v76
    v_dot2c_f32_bf16 v146, s98, v77
    v_dot2c_f32_bf16 v147, s99, v77
    v_dot2c_f32_bf16 v148, s98, v78
    v_dot2c_f32_bf16 v149, s99, v78
    v_dot2c_f32_bf16 v150, s98, v79
    v_dot2c_f32_bf16 v151, s99, v79
    buffer_load_dwordx4 v[128:131], v20, s[12:15], s6 offen
    s_add_u32 s6, s6, 28672
    s_waitcnt vmcnt(12)
    v_dot2c_f32_bf16 v144, s98, v80
    v_dot2c_f32_bf16 v145, s99, v80
    v_dot2c_f32_bf16 v146, s98, v81
    v_dot2c_f32_bf16 v147, s99, v81
    v_dot2c_f32_bf16 v148, s98, v82
    v_dot2c_f32_bf16 v149, s99, v82
    v_dot2c_f32_bf16 v150, s98, v83
    v_dot2c_f32_bf16 v151, s99, v83
    buffer_load_dwordx4 v[132:135], v20, s[12:15], s6 offen
    s_add_u32 s6, s6, 28672
    s_waitcnt vmcnt(12)
    v_dot2c_f32_bf16 v144, s98, v84
    v_dot2c_f32_bf16 v145, s99, v84
    v_dot2c_f32_bf16 v146, s98, v85
    v_dot2c_f32_bf16 v147, s99, v85
    v_dot2c_f32_bf16 v148, s98, v86
    v_dot2c_f32_bf16 v149, s99, v86
    v_dot2c_f32_bf16 v150, s98, v87
    v_dot2c_f32_bf16 v151, s99, v87
    buffer_load_dwordx4 v[136:139], v20, s[12:15], s6 offen
    s_add_u32 s6, s6, 28672
    s_waitcnt vmcnt(12)
    v_dot2c_f32_bf16 v144, s98, v88
    v_dot2c_f32_bf16 v145, s99, v88
    v_dot2c_f32_bf16 v146, s98, v89
    v_dot2c_f32_bf16 v147, s99, v89
    v_dot2c_f32_bf16 v148, s98, v90
    v_dot2c_f32_bf16 v149, s99, v90
    v_dot2c_f32_bf16 v150, s98, v91
    v_dot2c_f32_bf16 v151, s99, v91
    buffer_load_dwordx4 v[140:143], v20, s[12:15], s6 offen
    s_add_u32 s6, s6, 28672
    s_waitcnt vmcnt(12)
    v_dot2c_f32_bf16 v144, s98, v92
    v_dot2c_f32_bf16 v145, s99, v92
    v_dot2c_f32_bf16 v146, s98, v93
    v_dot2c_f32_bf16 v147, s99, v93
    v_dot2c_f32_bf16 v148, s98, v94
    v_dot2c_f32_bf16 v149, s99, v94
    v_dot2c_f32_bf16 v150, s98, v95
    v_dot2c_f32_bf16 v151, s99, v95
    s_waitcnt vmcnt(11)
    v_dot2c_f32_bf16 v144, s98, v96
    v_dot2c_f32_bf16 v145, s99, v96
    v_dot2c_f32_bf16 v146, s98, v97
    v_dot2c_f32_bf16 v147, s99, v97
    v_dot2c_f32_bf16 v148, s98, v98
    v_dot2c_f32_bf16 v149, s99, v98
    v_dot2c_f32_bf16 v150, s98, v99
    v_dot2c_f32_bf16 v151, s99, v99
    s_waitcnt vmcnt(10)
    v_dot2c_f32_bf16 v144, s98, v100
    v_dot2c_f32_bf16 v145, s99, v100
    v_dot2c_f32_bf16 v146, s98, v101
    v_dot2c_f32_bf16 v147, s99, v101
    v_dot2c_f32_bf16 v148, s98, v102
    v_dot2c_f32_bf16 v149, s99, v102
    v_dot2c_f32_bf16 v150, s98, v103
    v_dot2c_f32_bf16 v151, s99, v103
    s_waitcnt vmcnt(9)
    v_dot2c_f32_bf16 v144, s98, v104
    v_dot2c_f32_bf16 v145, s99, v104
    v_dot2c_f32_bf16 v146, s98, v105
    v_dot2c_f32_bf16 v147, s99, v105
    v_dot2c_f32_bf16 v148, s98, v106
    v_dot2c_f32_bf16 v149, s99, v106
    v_dot2c_f32_bf16 v150, s98, v107
    v_dot2c_f32_bf16 v151, s99, v107
    s_waitcnt vmcnt(8)
    v_dot2c_f32_bf16 v144, s98, v108
    v_dot2c_f32_bf16 v145, s99, v108
    v_dot2c_f32_bf16 v146, s98, v109
    v_dot2c_f32_bf16 v147, s99, v109
    v_dot2c_f32_bf16 v148, s98, v110
    v_dot2c_f32_bf16 v149, s99, v110
    v_dot2c_f32_bf16 v150, s98, v111
    v_dot2c_f32_bf16 v151, s99, v111
    s_waitcnt vmcnt(7)
    v_dot2c_f32_bf16 v144, s98, v112
    v_dot2c_f32_bf16 v145, s99, v112
    v_dot2c_f32_bf16 v146, s98, v113
    v_dot2c_f32_bf16 v147, s99, v113
    v_dot2c_f32_bf16 v148, s98, v114
    v_dot2c_f32_bf16 v149, s99, v114
    v_dot2c_f32_bf16 v150, s98, v115
    v_dot2c_f32_bf16 v151, s99, v115
    s_waitcnt vmcnt(6)
    v_dot2c_f32_bf16 v144, s98, v116
    v_dot2c_f32_bf16 v145, s99, v116
    v_dot2c_f32_bf16 v146, s98, v117
    v_dot2c_f32_bf16 v147, s99, v117
    v_dot2c_f32_bf16 v148, s98, v118
    v_dot2c_f32_bf16 v149, s99, v118
    v_dot2c_f32_bf16 v150, s98, v119
    v_dot2c_f32_bf16 v151, s99, v119
    s_waitcnt vmcnt(5)
    v_dot2c_f32_bf16 v144, s98, v120
    v_dot2c_f32_bf16 v145, s99, v120
    v_dot2c_f32_bf16 v146, s98, v121
    v_dot2c_f32_bf16 v147, s99, v121
    v_dot2c_f32_bf16 v148, s98, v122
    v_dot2c_f32_bf16 v149, s99, v122
    v_dot2c_f32_bf16 v150, s98, v123
    v_dot2c_f32_bf16 v151, s99, v123
    s_waitcnt vmcnt(4)
    v_dot2c_f32_bf16 v144, s98, v124
    v_dot2c_f32_bf16 v145, s99, v124
    v_dot2c_f32_bf16 v146, s98, v125
    v_dot2c_f32_bf16 v147, s99, v125
    v_dot2c_f32_bf16 v148, s98, v126
    v_dot2c_f32_bf16 v149, s99, v126
    v_dot2c_f32_bf16 v150, s98, v127
    v_dot2c_f32_bf16 v151, s99, v127
    s_waitcnt vmcnt(3)
    v_dot2c_f32_bf16 v144, s98, v128
    v_dot2c_f32_bf16 v145, s99, v128
    v_dot2c_f32_bf16 v146, s98, v129
    v_dot2c_f32_bf16 v147, s99, v129
    v_dot2c_f32_bf16 v148, s98, v130
    v_dot2c_f32_bf16 v149, s99, v130
    v_dot2c_f32_bf16 v150, s98, v131
    v_dot2c_f32_bf16 v151, s99, v131
    s_waitcnt vmcnt(2)
    v_dot2c_f32_bf16 v144, s98, v132
    v_dot2c_f32_bf16 v145, s99, v132
    v_dot2c_f32_bf16 v146, s98, v133
    v_dot2c_f32_bf16 v147, s99, v133
    v_dot2c_f32_bf16 v148, s98, v134
    v_dot2c_f32_bf16 v149, s99, v134
    v_dot2c_f32_bf16 v150, s98, v135
    v_dot2c_f32_bf16 v151, s99, v135
    s_waitcnt vmcnt(1)
    v_dot2c_f32_bf16 v144, s98, v136
    v_dot2c_f32_bf16 v145, s99, v136
    v_dot2c_f32_bf16 v146, s98, v137
    v_dot2c_f32_bf16 v147, s99, v137
    v_dot2c_f32_bf16 v148, s98, v138
    v_dot2c_f32_bf16 v149, s99, v138
    v_dot2c_f32_bf16 v150, s98, v139
    v_dot2c_f32_bf16 v151, s99, v139
    s_waitcnt vmcnt(0)
    v_dot2c_f32_bf16 v144, s98, v140
    v_dot2c_f32_bf16 v145, s99, v140
    v_dot2c_f32_bf16 v146, s98, v141
    v_dot2c_f32_bf16 v147, s99, v141
    v_dot2c_f32_bf16 v148, s98, v142
    v_dot2c_f32_bf16 v149, s99, v142
    v_dot2c_f32_bf16 v150, s98, v143
    v_dot2c_f32_bf16 v151, s99, v143
    v_permlane32_swap_b32 v144, v148
    v_permlane32_swap_b32 v145, v149
    v_permlane32_swap_b32 v146, v150
    v_permlane32_swap_b32 v147, v151
    v_add_f32 v144, v144, v148
    v_add_f32 v145, v145, v149
    v_add_f32 v146, v146, v150
    v_add_f32 v147, v147, v151
    s_nop 0
    v_permlane16_swap_b32 v144, v146
    v_permlane16_swap_b32 v145, v147
    v_add_f32 v144, v144, v146
    v_add_f32 v145, v145, v147
    s_nop 0
    v_add_f32_dpp v144, v144, v144 row_ror:8 row_mask:0xf bank_mask:0xf
    v_add_f32_dpp v145, v145, v145 row_ror:8 row_mask:0xf bank_mask:0xf
    s_mov_b32 vcc_lo, 0xff00ff00
    s_mov_b32 vcc_hi, 0xff00ff00
    v_cndmask_b32 v144, v144, v145, vcc
    v_xor_b32 v145, s40, v144
    s_mul_i32 s7, s87, 56
    s_add_u32 s5, s5, s7
    s_lshl_b32 s5, s5, 9
    s_add_u32 s5, s5, 720896
    buffer_store_dwordx2 v[144:145], v22, s[36:39], s5 offen sc1
L_help2:
    s_lshl1_add_u32 s4, s44, s45
    s_lshl2_add_u32 s4, s4, s3
    s_mul_i32 s4, s4, 12544
    v_min_u32 v23, 48, v1
    v_lshlrev_b32 v23, 8, v23
    buffer_load_dword v160, v23, s[28:31], s4 offen
    buffer_load_dword v161, v23, s[28:31], s4 offen offset:128
    buffer_store_dwordx4 a[248:251], v15, s[36:39], s88 offen sc1
    s_add_u32 s88, s88, 1024
    buffer_store_dwordx4 a[248:251], v15, s[36:39], s88 offen sc1
    s_add_u32 s88, s88, 1024
    buffer_store_dwordx4 a[248:251], v15, s[36:39], s88 offen sc1
    s_add_u32 s88, s88, 1024
    buffer_store_dwordx4 a[248:251], v15, s[36:39], s88 offen sc1
    s_add_u32 s88, s88, 1024
    buffer_store_dwordx4 a[248:251], v15, s[36:39], s88 offen sc1
    s_add_u32 s88, s88, 1024
    buffer_store_dwordx4 a[248:251], v15, s[36:39], s88 offen sc1
    s_add_u32 s88, s88, 1024
    buffer_store_dwordx4 a[248:251], v15, s[36:39], s88 offen sc1
    s_add_u32 s88, s88, 1024
    buffer_store_dwordx4 a[248:251], v15, s[36:39], s88 offen sc1
    s_add_u32 s88, s88, 1024
    buffer_store_dwordx4 a[248:251], v15, s[36:39], s88 offen sc1
    s_add_u32 s88, s88, 1024
    buffer_store_dwordx4 a[248:251], v15, s[36:39], s88 offen sc1
    s_add_u32 s88, s88, 1024
    buffer_store_dwordx4 a[248:251], v15, s[36:39], s88 offen sc1
    s_add_u32 s88, s88, 1024
    buffer_store_dwordx4 a[248:251], v15, s[36:39], s88 offen sc1
    s_add_u32 s88, s88, 1024
    buffer_store_dwordx4 a[248:251], v15, s[36:39], s88 offen sc1
    s_add_u32 s88, s88, 1024
    buffer_store_dwordx4 a[248:251], v15, s[36:39], s88 offen sc1
    s_add_u32 s88, s88, 101376
    s_waitcnt vmcnt(0)
    s_barrier
    s_cmp_lg_u32 s3, 0
    s_cbranch_scc1 L_hp_17
    s_mov_b64 exec, 0xff
    buffer_store_dwordx4 v[152:155], v15, s[36:39], s89 offen sc1
    s_mov_b64 exec, -1
L_hp_17:
    s_add_u32 s89, s89, 4096
    buffer_store_dwordx4 a[248:251], v15, s[36:39], s88 offen sc1
    s_add_u32 s88, s88, 1024
    buffer_store_dwordx4 a[248:251], v15, s[36:39], s88 offen sc1
    s_add_u32 s88, s88, 1024
    buffer_store_dwordx4 a[248:251], v15, s[36:39], s88 offen sc1
    s_add_u32 s88, s88, 1024
    buffer_store_dwordx4 a[248:251], v15, s[36:39], s88 offen sc1
    s_add_u32 s88, s88, 1024
    buffer_store_dwordx4 a[248:251], v15, s[36:39], s88 offen sc1
    s_add_u32 s88, s88, 1024
    buffer_store_dwordx4 a[248:251], v15, s[36:39], s88 offen sc1
    s_add_u32 s88, s88, 1024
    buffer_store_dwordx4 a[248:251], v15, s[36:39], s88 offen sc1
    s_add_u32 s88, s88, 1024
    buffer_store_dwordx4 a[248:251], v15, s[36:39], s88 offen sc1
    s_add_u32 s88, s88, 1024
    buffer_store_dwordx4 a[248:251], v15, s[36:39], s88 offen sc1
    s_add_u32 s88, s88, 1024
    buffer_store_dwordx4 a[248:251], v15, s[36:39], s88 offen sc1
    s_add_u32 s88, s88, 1024
    buffer_store_dwordx4 a[248:251], v15, s[36:39], s88 offen sc1
    s_add_u32 s88, s88, 1024
    buffer_store_dwordx4 a[248:251], v15, s[36:39], s88 offen sc1
    s_add_u32 s88, s88, 1024
    buffer_store_dwordx4 a[248:251], v15, s[36:39], s88 offen sc1
    s_add_u32 s88, s88, 1024
    buffer_store_dwordx4 a[248:251], v15, s[36:39], s88 offen sc1
    s_add_u32 s88, s88, 101376
    s_waitcnt vmcnt(0)
    s_barrier
    s_cmp_lg_u32 s3, 0
    s_cbranch_scc1 L_hp_18
    s_mov_b64 exec, 0xff
    buffer_store_dwordx4 v[152:155], v15, s[36:39], s89 offen sc1
    s_mov_b64 exec, -1
L_hp_18:
    s_add_u32 s89, s89, 4096
    s_branch L_fin
L_sv_1:
    s_mov_b32 s55, 0
L_sv_1_t:
    s_sleep 2
    buffer_load_dwordx4 v[192:195], v150, s[36:39], s93 offen sc1
    s_waitcnt vmcnt(0)
    v_bitop3_b32 v193, s40, v192, v193 bitop3:0x96
    v_bitop3_b32 v195, s40, v194, v195 bitop3:0x96
    v_or_b32 v193, v193, v195
    v_cmp_ne_u32 vcc, 0, v193
    s_cbranch_vccz L_svb_2
    s_add_u32 s55, s55, 1
    s_cmp_lt_u32 s55, 200000
    s_cbranch_scc1 L_sv_1_t
    s_branch L_svb_2
L_cc_4:
    s_mov_b32 s55, 0
L_cc_4_t:
    buffer_load_dword v166, v175, s[36:39], s41 offen sc1
    s_waitcnt vmcnt(0)
    v_cmp_ne_u32 vcc, s40, v166
    s_cbranch_vccz L_cb_5
    s_sleep 2
    s_add_u32 s55, s55, 1
    s_cmp_lt_u32 s55, 200000
    s_cbranch_scc1 L_cc_4_t
    s_branch L_cb_5
R_ool_7:
    s_mov_b32 s55, 0
R_ool_7_t:
    s_waitcnt vmcnt(0)
    s_mov_b32 s64, 0
    v_max3_u32 v20, v224, v225, v226
    v_max3_u32 v20, v20, v227, v227
    v_cmp_eq_u32 vcc, -1, v20
    s_cbranch_vccz R_s_9
    buffer_load_dwordx4 v[224:227], v15, s[36:39], s43 offen sc1
    s_mov_b32 s64, 1
R_s_9:
    v_max3_u32 v20, v228, v229, v230
    v_max3_u32 v20, v20, v231, v231
    v_cmp_eq_u32 vcc, -1, v20
    s_cbranch_vccz R_s_10
    buffer_load_dwordx4 v[228:231], v15, s[36:39], s43 offen offset:1024 sc1
    s_mov_b32 s64, 1
R_s_10:
    v_max3_u32 v20, v232, v233, v234
    v_max3_u32 v20, v20, v235, v235
    v_cmp_eq_u32 vcc, -1, v20
    s_cbranch_vccz R_s_11
    buffer_load_dwordx4 v[232:235], v15, s[36:39], s43 offen offset:2048 sc1
    s_mov_b32 s64, 1
R_s_11:
    v_max3_u32 v20, v236, v237, v238
    v_max3_u32 v20, v20, v239, v239
    v_cmp_eq_u32 vcc, -1, v20
    s_cbranch_vccz R_s_12
    buffer_load_dwordx4 v[236:239], v15, s[36:39], s43 offen offset:3072 sc1
    s_mov_b32 s64, 1
R_s_12:
    v_max3_u32 v20, v240, v241, v242
    v_max3_u32 v20, v20, v243, v243
    v_cmp_eq_u32 vcc, -1, v20
    s_cbranch_vccz R_s_13
    buffer_load_dwordx4 v[240:243], v15, s[36:39], s65 offen sc1
    s_mov_b32 s64, 1
R_s_13:
    v_max3_u32 v20, v244, v245, v246
    v_max3_u32 v20, v20, v247, v247
    v_cmp_eq_u32 vcc, -1, v20
    s_cbranch_vccz R_s_14
    buffer_load_dwordx4 v[244:247], v15, s[36:39], s65 offen offset:1024 sc1
    s_mov_b32 s64, 1
R_s_14:
    v_max3_u32 v20, v248, v249, v250
    v_max3_u32 v20, v20, v251, v251
    v_cmp_eq_u32 vcc, -1, v20
    s_cbranch_vccz R_s_15
    buffer_load_dwordx4 v[248:251], v15, s[36:39], s65 offen offset:2048 sc1
    s_mov_b32 s64, 1
R_s_15:
    v_max3_u32 v20, v252, v253, v254
    v_max3_u32 v20, v20, v255, v255
    v_cmp_eq_u32 vcc, -1, v20
    s_cbranch_vccz R_s_16
    buffer_load_dwordx4 v[252:255], v15, s[36:39], s65 offen offset:3072 sc1
    s_mov_b32 s64, 1
R_s_16:
    s_add_u32 s55, s55, s64
    s_cmp_eq_u32 s55, 0
    s_cbranch_scc1 R_done_8
    s_cmp_eq_u32 s64, 0
    s_cbranch_scc1 R_top_6
    s_cmp_lt_u32 s55, 200000
    s_cbranch_scc1 R_ool_7_t
    s_waitcnt vmcnt(0)
    s_branch R_done_8
S_ool_19:
    s_mov_b32 s55, 0
S_ool_19_t:
    s_waitcnt vmcnt(0)
    s_mov_b32 s64, 0
    v_add3_u32 v20, v160, v161, s40
    v_add3_u32 v20, v20, v162, v163
    v_add3_u32 v20, v20, v164, v165
    v_add_u32 v20, v20, v166
    v_cmp_ne_u32 vcc, v167, v20
    s_cbranch_vccz S_s_21
    buffer_load_dwordx4 v[160:163], v15, s[36:39], s79 offen sc1
    buffer_load_dwordx4 v[164:167], v15, s[36:39], s79 offen offset:1024 sc1
    s_mov_b32 s64, 1
S_s_21:
    v_add3_u32 v20, v168, v169, s40
    v_add3_u32 v20, v20, v170, v171
    v_add3_u32 v20, v20, v172, v173
    v_add_u32 v20, v20, v174
    v_cmp_ne_u32 vcc, v175, v20
    s_cbranch_vccz S_s_22
    buffer_load_dwordx4 v[168:171], v15, s[36:39], s80 offen sc1
    buffer_load_dwordx4 v[172:175], v15, s[36:39], s80 offen offset:1024 sc1
    s_mov_b32 s64, 1
S_s_22:
    v_add3_u32 v20, v176, v177, s40
    v_add3_u32 v20, v20, v178, v179
    v_add3_u32 v20, v20, v180, v181
    v_add_u32 v20, v20, v182
    v_cmp_ne_u32 vcc, v183, v20
    s_cbranch_vccz S_s_23
    buffer_load_dwordx4 v[176:179], v15, s[36:39], s81 offen sc1
    buffer_load_dwordx4 v[180:183], v15, s[36:39], s81 offen offset:1024 sc1
    s_mov_b32 s64, 1
S_s_23:
    v_add3_u32 v20, v184, v185, s40
    v_add3_u32 v20, v20, v186, v187
    v_add3_u32 v20, v20, v188, v189
    v_add_u32 v20, v20, v190
    v_cmp_ne_u32 vcc, v191, v20
    s_cbranch_vccz S_s_24
    buffer_load_dwordx4 v[184:187], v15, s[36:39], s82 offen sc1
    buffer_load_dwordx4 v[188:191], v15, s[36:39], s82 offen offset:1024 sc1
    s_mov_b32 s64, 1
S_s_24:
    v_add3_u32 v20, v192, v193, s40
    v_add3_u32 v20, v20, v194, v195
    v_add3_u32 v20, v20, v196, v197
    v_add_u32 v20, v20, v198
    v_cmp_ne_u32 vcc, v199, v20
    s_cbranch_vccz S_s_25
    buffer_load_dwordx4 v[192:195], v15, s[36:39], s83 offen sc1
    buffer_load_dwordx4 v[196:199], v15, s[36:39], s83 offen offset:1024 sc1
    s_mov_b32 s64, 1
S_s_25:
    s_cmp_eq_u32 s64, 0
    s_cbranch_scc1 S_bk_20
    s_add_u32 s55, s55, 1
    s_cmp_lt_u32 s55, 200000
    s_cbranch_scc1 S_ool_19_t
    s_waitcnt vmcnt(0)
    s_branch S_bk_20
S_ool_26:
    s_mov_b32 s55, 0
S_ool_26_t:
    s_waitcnt vmcnt(0)
    s_mov_b32 s64, 0
    v_add3_u32 v20, v168, v169, s40
    v_add3_u32 v20, v20, v170, v171
    v_add3_u32 v20, v20, v172, v173
    v_add_u32 v20, v20, v174
    v_cmp_ne_u32 vcc, v175, v20
    s_cbranch_vccz S_s_28
    buffer_load_dwordx4 v[168:171], v15, s[36:39], s80 offen sc1
    buffer_load_dwordx4 v[172:175], v15, s[36:39], s80 offen offset:1024 sc1
    s_mov_b32 s64, 1
S_s_28:
    v_add3_u32 v20, v176, v177, s40
    v_add3_u32 v20, v20, v178, v179
    v_add3_u32 v20, v20, v180, v181
    v_add_u32 v20, v20, v182
    v_cmp_ne_u32 vcc, v183, v20
    s_cbranch_vccz S_s_29
    buffer_load_dwordx4 v[176:179], v15, s[36:39], s81 offen sc1
    buffer_load_dwordx4 v[180:183], v15, s[36:39], s81 offen offset:1024 sc1
    s_mov_b32 s64, 1
S_s_29:
    v_add3_u32 v20, v184, v185, s40
    v_add3_u32 v20, v20, v186, v187
    v_add3_u32 v20, v20, v188, v189
    v_add_u32 v20, v20, v190
    v_cmp_ne_u32 vcc, v191, v20
    s_cbranch_vccz S_s_30
    buffer_load_dwordx4 v[184:187], v15, s[36:39], s82 offen sc1
    buffer_load_dwordx4 v[188:191], v15, s[36:39], s82 offen offset:1024 sc1
    s_mov_b32 s64, 1
S_s_30:
    v_add3_u32 v20, v192, v193, s40
    v_add3_u32 v20, v20, v194, v195
    v_add3_u32 v20, v20, v196, v197
    v_add_u32 v20, v20, v198
    v_cmp_ne_u32 vcc, v199, v20
    s_cbranch_vccz S_s_31
    buffer_load_dwordx4 v[192:195], v15, s[36:39], s83 offen sc1
    buffer_load_dwordx4 v[196:199], v15, s[36:39], s83 offen offset:1024 sc1
    s_mov_b32 s64, 1
S_s_31:
    s_cmp_eq_u32 s64, 0
    s_cbranch_scc1 S_bk_27
    s_add_u32 s55, s55, 1
    s_cmp_lt_u32 s55, 200000
    s_cbranch_scc1 S_ool_26_t
    s_waitcnt vmcnt(0)
    s_branch S_bk_27
S_ool_32:
    s_mov_b32 s55, 0
S_ool_32_t:
    s_waitcnt vmcnt(0)
    s_mov_b32 s64, 0
    v_add3_u32 v20, v176, v177, s40
    v_add3_u32 v20, v20, v178, v179
    v_add3_u32 v20, v20, v180, v181
    v_add_u32 v20, v20, v182
    v_cmp_ne_u32 vcc, v183, v20
    s_cbranch_vccz S_s_34
    buffer_load_dwordx4 v[176:179], v15, s[36:39], s81 offen sc1
    buffer_load_dwordx4 v[180:183], v15, s[36:39], s81 offen offset:1024 sc1
    s_mov_b32 s64, 1
S_s_34:
    v_add3_u32 v20, v184, v185, s40
    v_add3_u32 v20, v20, v186, v187
    v_add3_u32 v20, v20, v188, v189
    v_add_u32 v20, v20, v190
    v_cmp_ne_u32 vcc, v191, v20
    s_cbranch_vccz S_s_35
    buffer_load_dwordx4 v[184:187], v15, s[36:39], s82 offen sc1
    buffer_load_dwordx4 v[188:191], v15, s[36:39], s82 offen offset:1024 sc1
    s_mov_b32 s64, 1
S_s_35:
    v_add3_u32 v20, v192, v193, s40
    v_add3_u32 v20, v20, v194, v195
    v_add3_u32 v20, v20, v196, v197
    v_add_u32 v20, v20, v198
    v_cmp_ne_u32 vcc, v199, v20
    s_cbranch_vccz S_s_36
    buffer_load_dwordx4 v[192:195], v15, s[36:39], s83 offen sc1
    buffer_load_dwordx4 v[196:199], v15, s[36:39], s83 offen offset:1024 sc1
    s_mov_b32 s64, 1
S_s_36:
    s_cmp_eq_u32 s64, 0
    s_cbranch_scc1 S_bk_33
    s_add_u32 s55, s55, 1
    s_cmp_lt_u32 s55, 200000
    s_cbranch_scc1 S_ool_32_t
    s_waitcnt vmcnt(0)
    s_branch S_bk_33
S_ool_37:
    s_mov_b32 s55, 0
S_ool_37_t:
    s_waitcnt vmcnt(0)
    s_mov_b32 s64, 0
    v_add3_u32 v20, v184, v185, s40
    v_add3_u32 v20, v20, v186, v187
    v_add3_u32 v20, v20, v188, v189
    v_add_u32 v20, v20, v190
    v_cmp_ne_u32 vcc, v191, v20
    s_cbranch_vccz S_s_39
    buffer_load_dwordx4 v[184:187], v15, s[36:39], s82 offen sc1
    buffer_load_dwordx4 v[188:191], v15, s[36:39], s82 offen offset:1024 sc1
    s_mov_b32 s64, 1
S_s_39:
    v_add3_u32 v20, v192, v193, s40
    v_add3_u32 v20, v20, v194, v195
    v_add3_u32 v20, v20, v196, v197
    v_add_u32 v20, v20, v198
    v_cmp_ne_u32 vcc, v199, v20
    s_cbranch_vccz S_s_40
    buffer_load_dwordx4 v[192:195], v15, s[36:39], s83 offen sc1
    buffer_load_dwordx4 v[196:199], v15, s[36:39], s83 offen offset:1024 sc1
    s_mov_b32 s64, 1
S_s_40:
    s_cmp_eq_u32 s64, 0
    s_cbranch_scc1 S_bk_38
    s_add_u32 s55, s55, 1
    s_cmp_lt_u32 s55, 200000
    s_cbranch_scc1 S_ool_37_t
    s_waitcnt vmcnt(0)
    s_branch S_bk_38
S_ool_41:
    s_mov_b32 s55, 0
S_ool_41_t:
    s_waitcnt vmcnt(0)
    s_mov_b32 s64, 0
    v_add3_u32 v20, v192, v193, s40
    v_add3_u32 v20, v20, v194, v195
    v_add3_u32 v20, v20, v196, v197
    v_add_u32 v20, v20, v198
    v_cmp_ne_u32 vcc, v199, v20
    s_cbranch_vccz S_s_43
    buffer_load_dwordx4 v[192:195], v15, s[36:39], s83 offen sc1
    buffer_load_dwordx4 v[196:199], v15, s[36:39], s83 offen offset:1024 sc1
    s_mov_b32 s64, 1
S_s_43:
    s_cmp_eq_u32 s64, 0
    s_cbranch_scc1 S_bk_42
    s_add_u32 s55, s55, 1
    s_cmp_lt_u32 s55, 200000
    s_cbranch_scc1 S_ool_41_t
    s_waitcnt vmcnt(0)
    s_branch S_bk_42
S_ool_44:
    s_mov_b32 s55, 0
S_ool_44_t:
    s_waitcnt vmcnt(0)
    s_mov_b32 s64, 0
    v_add3_u32 v20, v200, v201, s40
    v_add3_u32 v20, v20, v202, v203
    v_add3_u32 v20, v20, v204, v205
    v_add_u32 v20, v20, v206
    v_cmp_ne_u32 vcc, v207, v20
    s_cbranch_vccz S_s_46
    buffer_load_dwordx4 v[200:203], v15, s[36:39], s84 offen sc1
    buffer_load_dwordx4 v[204:207], v15, s[36:39], s84 offen offset:1024 sc1
    s_mov_b32 s64, 1
S_s_46:
    v_add3_u32 v20, v208, v209, s40
    v_add3_u32 v20, v20, v210, v211
    v_add3_u32 v20, v20, v212, v213
    v_add_u32 v20, v20, v214
    v_cmp_ne_u32 vcc, v215, v20
    s_cbranch_vccz S_s_47
    buffer_load_dwordx4 v[208:211], v15, s[36:39], s85 offen sc1
    buffer_load_dwordx4 v[212:215], v15, s[36:39], s85 offen offset:1024 sc1
    s_mov_b32 s64, 1
S_s_47:
    v_add3_u32 v20, v216, v217, s40
    v_add3_u32 v20, v20, v218, v219
    v_add3_u32 v20, v20, v220, v221
    v_add_u32 v20, v20, v222
    v_cmp_ne_u32 vcc, v223, v20
    s_cbranch_vccz S_s_48
    buffer_load_dwordx4 v[216:219], v15, s[36:39], s86 offen sc1
    buffer_load_dwordx4 v[220:223], v15, s[36:39], s86 offen offset:1024 sc1
    s_mov_b32 s64, 1
S_s_48:
    s_cmp_eq_u32 s64, 0
    s_cbranch_scc1 S_bk_45
    s_add_u32 s55, s55, 1
    s_cmp_lt_u32 s55, 200000
    s_cbranch_scc1 S_ool_44_t
    s_waitcnt vmcnt(0)
    s_branch S_bk_45
S_ool_49:
    s_mov_b32 s55, 0
S_ool_49_t:
    s_waitcnt vmcnt(0)
    s_mov_b32 s64, 0
    v_add3_u32 v20, v208, v209, s40
    v_add3_u32 v20, v20, v210, v211
    v_add3_u32 v20, v20, v212, v213
    v_add_u32 v20, v20, v214
    v_cmp_ne_u32 vcc, v215, v20
    s_cbranch_vccz S_s_51
    buffer_load_dwordx4 v[208:211], v15, s[36:39], s85 offen sc1
    buffer_load_dwordx4 v[212:215], v15, s[36:39], s85 offen offset:1024 sc1
    s_mov_b32 s64, 1
S_s_51:
    v_add3_u32 v20, v216, v217, s40
    v_add3_u32 v20, v20, v218, v219
    v_add3_u32 v20, v20, v220, v221
    v_add_u32 v20, v20, v222
    v_cmp_ne_u32 vcc, v223, v20
    s_cbranch_vccz S_s_52
    buffer_load_dwordx4 v[216:219], v15, s[36:39], s86 offen sc1
    buffer_load_dwordx4 v[220:223], v15, s[36:39], s86 offen offset:1024 sc1
    s_mov_b32 s64, 1
S_s_52:
    s_cmp_eq_u32 s64, 0
    s_cbranch_scc1 S_bk_50
    s_add_u32 s55, s55, 1
    s_cmp_lt_u32 s55, 200000
    s_cbranch_scc1 S_ool_49_t
    s_waitcnt vmcnt(0)
    s_branch S_bk_50
S_ool_53:
    s_mov_b32 s55, 0
S_ool_53_t:
    s_waitcnt vmcnt(0)
    s_mov_b32 s64, 0
    v_add3_u32 v20, v216, v217, s40
    v_add3_u32 v20, v20, v218, v219
    v_add3_u32 v20, v20, v220, v221
    v_add_u32 v20, v20, v222
    v_cmp_ne_u32 vcc, v223, v20
    s_cbranch_vccz S_s_55
    buffer_load_dwordx4 v[216:219], v15, s[36:39], s86 offen sc1
    buffer_load_dwordx4 v[220:223], v15, s[36:39], s86 offen offset:1024 sc1
    s_mov_b32 s64, 1
S_s_55:
    s_cmp_eq_u32 s64, 0
    s_cbranch_scc1 S_bk_54
    s_add_u32 s55, s55, 1
    s_cmp_lt_u32 s55, 200000
    s_cbranch_scc1 S_ool_53_t
    s_waitcnt vmcnt(0)
    s_branch S_bk_54
L_hc_57:
    s_mov_b32 s43, m0
    s_mov_b32 s55, 0
L_hc_57_t:
    v_max3_u32 v21, v32, v33, v34
    v_max3_u32 v21, v21, v35, v35
    v_cmp_eq_u32 vcc, -1, v21
    s_cbranch_vccz L_hs_59
    s_add_u32 m0, s97, 98304
    s_nop 0
    buffer_load_dwordx4 v15, s[36:39], s65 offen sc1 lds
L_hs_59:
    v_max3_u32 v21, v36, v37, v38
    v_max3_u32 v21, v21, v39, v39
    v_cmp_eq_u32 vcc, -1, v21
    s_cbranch_vccz L_hs_60
    s_add_u32 m0, s97, 98304
    s_nop 0
    buffer_load_dwordx4 v15, s[36:39], s66 offen offset:1024 sc1 lds
L_hs_60:
    v_max3_u32 v21, v40, v41, v42
    v_max3_u32 v21, v21, v43, v43
    v_cmp_eq_u32 vcc, -1, v21
    s_cbranch_vccz L_hs_61
    s_add_u32 m0, s97, 98304
    s_nop 0
    buffer_load_dwordx4 v15, s[36:39], s67 offen offset:2048 sc1 lds
L_hs_61:
    v_max3_u32 v21, v44, v45, v46
    v_max3_u32 v21, v21, v47, v47
    v_cmp_eq_u32 vcc, -1, v21
    s_cbranch_vccz L_hs_62
    s_add_u32 m0, s97, 98304
    s_nop 0
    buffer_load_dwordx4 v15, s[36:39], s68 offen offset:3072 sc1 lds
L_hs_62:
    v_max3_u32 v21, v48, v49, v50
    v_max3_u32 v21, v21, v51, v51
    v_cmp_eq_u32 vcc, -1, v21
    s_cbranch_vccz L_hs_63
    s_add_u32 m0, s97, 102400
    s_nop 0
    buffer_load_dwordx4 v15, s[36:39], s69 offen sc1 lds
L_hs_63:
    v_max3_u32 v21, v52, v53, v54
    v_max3_u32 v21, v21, v55, v55
    v_cmp_eq_u32 vcc, -1, v21
    s_cbranch_vccz L_hs_64
    s_add_u32 m0, s97, 102400
    s_nop 0
    buffer_load_dwordx4 v15, s[36:39], s70 offen offset:1024 sc1 lds
L_hs_64:
    v_max3_u32 v21, v56, v57, v58
    v_max3_u32 v21, v21, v59, v59
    v_cmp_eq_u32 vcc, -1, v21
    s_cbranch_vccz L_hs_65
    s_add_u32 m0, s97, 102400
    s_nop 0
    buffer_load_dwordx4 v15, s[36:39], s71 offen offset:2048 sc1 lds
L_hs_65:
    s_waitcnt vmcnt(0)
    ds_read_b128 v[32:35], v8
    ds_read_b128 v[36:39], v8 offset:1024
    ds_read_b128 v[40:43], v8 offset:2048
    ds_read_b128 v[44:47], v8 offset:3072
    ds_read_b128 v[48:51], v8 offset:4096
    ds_read_b128 v[52:55], v8 offset:5120
    ds_read_b128 v[56:59], v8 offset:6144
    s_mov_b32 m0, s43
    s_waitcnt lgkmcnt(0)
    v_max3_u32 v21, v32, v33, v34
    v_max3_u32 v21, v21, v35, v36
    v_max3_u32 v21, v21, v37, v38
    v_max3_u32 v21, v21, v39, v40
    v_max3_u32 v21, v21, v41, v42
    v_max3_u32 v21, v21, v43, v44
    v_max3_u32 v21, v21, v45, v46
    v_max3_u32 v21, v21, v47, v48
    v_max3_u32 v21, v21, v49, v50
    v_max3_u32 v21, v21, v51, v52
    v_max3_u32 v21, v21, v53, v54
    v_max3_u32 v21, v21, v55, v56
    v_max3_u32 v21, v21, v57, v58
    v_max3_u32 v21, v21, v59, v59
    v_cmp_eq_u32 vcc, -1, v21
    s_cbranch_vccz L_hb_58
    s_add_u32 s55, s55, 1
    s_cmp_lt_u32 s55, 200000
    s_cbranch_scc1 L_hc_57_t
    s_branch L_hb_58
L_tg_66:
    s_mov_b32 s55, 0
L_tg_66_t:
    s_sleep 2
    buffer_load_dwordx2 v[232:233], v236, s[36:39], s60 offen sc1
    buffer_load_dwordx2 v[234:235], v236, s[36:39], s61 offen sc1
    s_waitcnt vmcnt(0)
    v_bitop3_b32 v233, s40, v232, v233 bitop3:0x96
    v_bitop3_b32 v235, s40, v234, v235 bitop3:0x96
    v_or_b32 v233, v233, v235
    v_cmp_ne_u32 vcc, 0, v233
    s_cbranch_vccz L_tb_67
    s_add_u32 s55, s55, 1
    s_cmp_lt_u32 s55, 200000
    s_cbranch_scc1 L_tg_66_t
    s_branch L_tb_67
L_chk_68:
    s_mov_b32 s55, 0
L_chk_68_t:
    buffer_load_dwordx4 v[240:243], v15, s[36:39], s86 offen sc1
    buffer_load_dwordx4 v[244:247], v15, s[36:39], s86 offen offset:1024 sc1
    buffer_load_dwordx4 v[248:251], v15, s[36:39], s86 offen offset:2048 sc1
    buffer_load_dwordx4 v[252:255], v15, s[36:39], s86 offen offset:2560 sc1
    s_waitcnt vmcnt(0)
    v_max3_u32 v20, v240, v241, v242
    v_max3_u32 v20, v20, v243, v244
    v_max3_u32 v20, v20, v245, v246
    v_max3_u32 v20, v20, v247, v248
    v_max3_u32 v20, v20, v249, v250
    v_max3_u32 v20, v20, v251, v252
    v_max3_u32 v20, v20, v253, v254
    v_max3_u32 v20, v20, v255, v255
    v_cmp_eq_u32 vcc, -1, v20
    s_cbranch_vccz L_bk_69
    s_add_u32 s55, s55, 1
    s_cmp_lt_u32 s55, 200000
    s_cbranch_scc1 L_chk_68_t
    s_branch L_bk_69
L_cc_70:
    s_mov_b32 s55, 0
L_cc_70_t:
    buffer_load_dword v23, v25, s[36:39], s41 offen sc1
    s_waitcnt vmcnt(0)
    v_cmp_ne_u32 vcc, s40, v23
    s_cbranch_vccz L_cb_71
    s_sleep 2
    s_add_u32 s55, s55, 1
    s_cmp_lt_u32 s55, 200000
    s_cbranch_scc1 L_cc_70_t
    s_branch L_cb_71
L_cc_72:
    s_mov_b32 s55, 0
L_cc_72_t:
    buffer_load_dword v23, v25, s[36:39], s62 offen sc1
    s_waitcnt vmcnt(0)
    v_cmp_ne_u32 vcc, s40, v23
    s_cbranch_vccz L_cb_73
    s_sleep 2
    s_add_u32 s55, s55, 1
    s_cmp_lt_u32 s55, 200000
    s_cbranch_scc1 L_cc_72_t
    s_branch L_cb_73
L_cc_74:
    s_mov_b32 s55, 0
L_cc_74_t:
    buffer_load_dword v21, v9, s[36:39], s60 offen sc1
    s_waitcnt vmcnt(0)
    v_cmp_ne_u32 vcc, s40, v21
    s_cbranch_vccz L_cb_75
    s_sleep 2
    s_add_u32 s55, s55, 1
    s_cmp_lt_u32 s55, 200000
    s_cbranch_scc1 L_cc_74_t
    s_branch L_cb_75
L_cc_76:
    s_mov_b32 s55, 0
L_cc_76_t:
    buffer_load_dword v21, v9, s[36:39], s61 offen sc1
    s_waitcnt vmcnt(0)
    v_cmp_ne_u32 vcc, s40, v21
    s_cbranch_vccz L_cb_77
    s_sleep 2
    s_add_u32 s55, s55, 1
    s_cmp_lt_u32 s55, 200000
    s_cbranch_scc1 L_cc_76_t
    s_branch L_cb_77
L_hc_78:
    s_mov_b32 s43, m0
    s_mov_b32 s55, 0
L_hc_78_t:
    v_max3_u32 v160, v64, v65, v66
    v_max3_u32 v160, v160, v67, v67
    v_cmp_eq_u32 vcc, -1, v160
    s_cbranch_vccz L_hs_80
    s_add_u32 m0, s97, 131072
    s_nop 0
    buffer_load_dwordx4 v28, s[36:39], s65 offen sc1 lds
L_hs_80:
    v_max3_u32 v160, v68, v69, v70
    v_max3_u32 v160, v160, v71, v71
    v_cmp_eq_u32 vcc, -1, v160
    s_cbranch_vccz L_hs_81
    s_add_u32 m0, s97, 131072
    s_nop 0
    buffer_load_dwordx4 v28, s[36:39], s66 offen offset:1024 sc1 lds
L_hs_81:
    v_max3_u32 v160, v72, v73, v74
    v_max3_u32 v160, v160, v75, v75
    v_cmp_eq_u32 vcc, -1, v160
    s_cbranch_vccz L_hs_82
    s_add_u32 m0, s97, 131072
    s_nop 0
    buffer_load_dwordx4 v28, s[36:39], s67 offen offset:2048 sc1 lds
L_hs_82:
    v_max3_u32 v160, v76, v77, v78
    v_max3_u32 v160, v160, v79, v79
    v_cmp_eq_u32 vcc, -1, v160
    s_cbranch_vccz L_hs_83
    s_add_u32 m0, s97, 131072
    s_nop 0
    buffer_load_dwordx4 v28, s[36:39], s68 offen offset:3072 sc1 lds
L_hs_83:
    v_max3_u32 v160, v80, v81, v82
    v_max3_u32 v160, v160, v83, v83
    v_cmp_eq_u32 vcc, -1, v160
    s_cbranch_vccz L_hs_84
    s_add_u32 m0, s97, 135168
    s_nop 0
    buffer_load_dwordx4 v28, s[36:39], s69 offen sc1 lds
L_hs_84:
    v_max3_u32 v160, v84, v85, v86
    v_max3_u32 v160, v160, v87, v87
    v_cmp_eq_u32 vcc, -1, v160
    s_cbranch_vccz L_hs_85
    s_add_u32 m0, s97, 135168
    s_nop 0
    buffer_load_dwordx4 v28, s[36:39], s70 offen offset:1024 sc1 lds
L_hs_85:
    v_max3_u32 v160, v88, v89, v90
    v_max3_u32 v160, v160, v91, v91
    v_cmp_eq_u32 vcc, -1, v160
    s_cbranch_vccz L_hs_86
    s_add_u32 m0, s97, 135168
    s_nop 0
    buffer_load_dwordx4 v28, s[36:39], s71 offen offset:2048 sc1 lds
L_hs_86:
    s_waitcnt vmcnt(0)
    ds_read_b128 v[64:67], v8 offset:32768
    ds_read_b128 v[68:71], v8 offset:33792
    ds_read_b128 v[72:75], v8 offset:34816
    ds_read_b128 v[76:79], v8 offset:35840
    ds_read_b128 v[80:83], v8 offset:36864
    ds_read_b128 v[84:87], v8 offset:37888
    ds_read_b128 v[88:91], v8 offset:38912
    s_mov_b32 m0, s43
    s_waitcnt lgkmcnt(0)
    v_max3_u32 v160, v64, v65, v66
    v_max3_u32 v160, v160, v67, v68
    v_max3_u32 v160, v160, v69, v70
    v_max3_u32 v160, v160, v71, v72
    v_max3_u32 v160, v160, v73, v74
    v_max3_u32 v160, v160, v75, v76
    v_max3_u32 v160, v160, v77, v78
    v_max3_u32 v160, v160, v79, v80
    v_max3_u32 v160, v160, v81, v82
    v_max3_u32 v160, v160, v83, v84
    v_max3_u32 v160, v160, v85, v86
    v_max3_u32 v160, v160, v87, v88
    v_max3_u32 v160, v160, v89, v90
    v_max3_u32 v160, v160, v91, v91
    v_cmp_eq_u32 vcc, -1, v160
    s_cbranch_vccz L_hb_79
    s_add_u32 s55, s55, 1
    s_cmp_lt_u32 s55, 200000
    s_cbranch_scc1 L_hc_78_t
    s_branch L_hb_79
L_nn_87:
    s_mov_b32 s55, 0
    v_subrev_u32 v27, 114688, v26
L_nn_87_t:
    buffer_load_dwordx4 a[0:3], v27, s[36:39], s79 offen sc1
    buffer_load_dwordx4 a[4:7], v27, s[36:39], s79 offen offset:2048 sc1
    buffer_load_dwordx4 a[8:11], v27, s[36:39], s80 offen sc1
    buffer_load_dwordx4 a[12:15], v27, s[36:39], s80 offen offset:2048 sc1
    buffer_load_dwordx4 a[16:19], v27, s[36:39], s81 offen sc1
    buffer_load_dwordx4 a[20:23], v27, s[36:39], s81 offen offset:2048 sc1
    buffer_load_dwordx4 a[24:27], v27, s[36:39], s82 offen sc1
    buffer_load_dwordx4 a[28:31], v27, s[36:39], s82 offen offset:2048 sc1
    buffer_load_dwordx4 a[32:35], v27, s[36:39], s83 offen sc1
    buffer_load_dwordx4 a[36:39], v27, s[36:39], s83 offen offset:2048 sc1
    buffer_load_dwordx4 a[40:43], v27, s[36:39], s84 offen sc1
    buffer_load_dwordx4 a[44:47], v27, s[36:39], s84 offen offset:2048 sc1
    buffer_load_dwordx4 a[48:51], v27, s[36:39], s85 offen sc1
    buffer_load_dwordx4 a[52:55], v27, s[36:39], s85 offen offset:2048 sc1
    v_mov_b32 v20, 0
    s_waitcnt vmcnt(13)
    v_accvgpr_read_b32 v21, a0
    v_accvgpr_read_b32 v22, a1
    v_max3_u32 v20, v20, v21, v22
    v_accvgpr_read_b32 v21, a2
    v_accvgpr_read_b32 v22, a3
    v_max3_u32 v20, v20, v21, v22
    v_mfma_f32_16x16x32_bf16 v[32:35], a[224:227], a[0:3], 0
    v_mfma_f32_16x16x32_bf16 v[36:39], a[228:231], a[0:3], 0
    v_mfma_f32_16x16x32_bf16 v[40:43], a[232:235], a[0:3], 0
    v_mfma_f32_16x16x32_bf16 v[44:47], a[236:239], a[0:3], 0
    s_waitcnt vmcnt(12)
    v_accvgpr_read_b32 v21, a4
    v_accvgpr_read_b32 v22, a5
    v_max3_u32 v20, v20, v21, v22
    v_accvgpr_read_b32 v21, a6
    v_accvgpr_read_b32 v22, a7
    v_max3_u32 v20, v20, v21, v22
    v_mfma_f32_16x16x32_bf16 v[32:35], a[240:243], a[4:7], v[32:35]
    v_mfma_f32_16x16x32_bf16 v[36:39], a[244:247], a[4:7], v[36:39]
    v_mfma_f32_16x16x32_bf16 v[40:43], a[248:251], a[4:7], v[40:43]
    v_mfma_f32_16x16x32_bf16 v[44:47], a[252:255], a[4:7], v[44:47]
    s_waitcnt vmcnt(11)
    v_accvgpr_read_b32 v21, a8
    v_accvgpr_read_b32 v22, a9
    v_max3_u32 v20, v20, v21, v22
    v_accvgpr_read_b32 v21, a10
    v_accvgpr_read_b32 v22, a11
    v_max3_u32 v20, v20, v21, v22
    v_mfma_f32_16x16x32_bf16 v[32:35], v[176:179], a[8:11], v[32:35]
    v_mfma_f32_16x16x32_bf16 v[36:39], v[180:183], a[8:11], v[36:39]
    v_mfma_f32_16x16x32_bf16 v[40:43], v[184:187], a[8:11], v[40:43]
    v_mfma_f32_16x16x32_bf16 v[44:47], v[188:191], a[8:11], v[44:47]
    s_waitcnt vmcnt(10)
    v_accvgpr_read_b32 v21, a12
    v_accvgpr_read_b32 v22, a13
    v_max3_u32 v20, v20, v21, v22
    v_accvgpr_read_b32 v21, a14
    v_accvgpr_read_b32 v22, a15
    v_max3_u32 v20, v20, v21, v22
    v_mfma_f32_16x16x32_bf16 v[32:35], v[192:195], a[12:15], v[32:35]
    v_mfma_f32_16x16x32_bf16 v[36:39], v[196:199], a[12:15], v[36:39]
    v_mfma_f32_16x16x32_bf16 v[40:43], v[200:203], a[12:15], v[40:43]
    v_mfma_f32_16x16x32_bf16 v[44:47], v[204:207], a[12:15], v[44:47]
    s_waitcnt vmcnt(9)
    v_accvgpr_read_b32 v21, a16
    v_accvgpr_read_b32 v22, a17
    v_max3_u32 v20, v20, v21, v22
    v_accvgpr_read_b32 v21, a18
    v_accvgpr_read_b32 v22, a19
    v_max3_u32 v20, v20, v21, v22
    v_mfma_f32_16x16x32_bf16 v[32:35], v[208:211], a[16:19], v[32:35]
    v_mfma_f32_16x16x32_bf16 v[36:39], v[212:215], a[16:19], v[36:39]
    v_mfma_f32_16x16x32_bf16 v[40:43], v[216:219], a[16:19], v[40:43]
    v_mfma_f32_16x16x32_bf16 v[44:47], v[220:223], a[16:19], v[44:47]
    s_waitcnt vmcnt(8)
    v_accvgpr_read_b32 v21, a20
    v_accvgpr_read_b32 v22, a21
    v_max3_u32 v20, v20, v21, v22
    v_accvgpr_read_b32 v21, a22
    v_accvgpr_read_b32 v22, a23
    v_max3_u32 v20, v20, v21, v22
    v_mfma_f32_16x16x32_bf16 v[32:35], v[224:227], a[20:23], v[32:35]
    v_mfma_f32_16x16x32_bf16 v[36:39], v[228:231], a[20:23], v[36:39]
    v_mfma_f32_16x16x32_bf16 v[40:43], v[232:235], a[20:23], v[40:43]
    v_mfma_f32_16x16x32_bf16 v[44:47], v[236:239], a[20:23], v[44:47]
    s_waitcnt vmcnt(7)
    v_accvgpr_read_b32 v21, a24
    v_accvgpr_read_b32 v22, a25
    v_max3_u32 v20, v20, v21, v22
    v_accvgpr_read_b32 v21, a26
    v_accvgpr_read_b32 v22, a27
    v_max3_u32 v20, v20, v21, v22
    v_mfma_f32_16x16x32_bf16 v[32:35], v[240:243], a[24:27], v[32:35]
    v_mfma_f32_16x16x32_bf16 v[36:39], v[244:247], a[24:27], v[36:39]
    v_mfma_f32_16x16x32_bf16 v[40:43], v[248:251], a[24:27], v[40:43]
    v_mfma_f32_16x16x32_bf16 v[44:47], v[252:255], a[24:27], v[44:47]
    s_waitcnt vmcnt(6)
    v_accvgpr_read_b32 v21, a28
    v_accvgpr_read_b32 v22, a29
    v_max3_u32 v20, v20, v21, v22
    v_accvgpr_read_b32 v21, a30
    v_accvgpr_read_b32 v22, a31
    v_max3_u32 v20, v20, v21, v22
    v_mfma_f32_16x16x32_bf16 v[32:35], a[112:115], a[28:31], v[32:35]
    v_mfma_f32_16x16x32_bf16 v[36:39], a[116:119], a[28:31], v[36:39]
    v_mfma_f32_16x16x32_bf16 v[40:43], a[120:123], a[28:31], v[40:43]
    v_mfma_f32_16x16x32_bf16 v[44:47], a[124:127], a[28:31], v[44:47]
    s_waitcnt vmcnt(5)
    v_accvgpr_read_b32 v21, a32
    v_accvgpr_read_b32 v22, a33
    v_max3_u32 v20, v20, v21, v22
    v_accvgpr_read_b32 v21, a34
    v_accvgpr_read_b32 v22, a35
    v_max3_u32 v20, v20, v21, v22
    v_mfma_f32_16x16x32_bf16 v[32:35], a[128:131], a[32:35], v[32:35]
    v_mfma_f32_16x16x32_bf16 v[36:39], a[132:135], a[32:35], v[36:39]
    v_mfma_f32_16x16x32_bf16 v[40:43], a[136:139], a[32:35], v[40:43]
    v_mfma_f32_16x16x32_bf16 v[44:47], a[140:143], a[32:35], v[44:47]
    s_waitcnt vmcnt(4)
    v_accvgpr_read_b32 v21, a36
    v_accvgpr_read_b32 v22, a37
    v_max3_u32 v20, v20, v21, v22
    v_accvgpr_read_b32 v21, a38
    v_accvgpr_read_b32 v22, a39
    v_max3_u32 v20, v20, v21, v22
    v_mfma_f32_16x16x32_bf16 v[32:35], a[144:147], a[36:39], v[32:35]
    v_mfma_f32_16x16x32_bf16 v[36:39], a[148:151], a[36:39], v[36:39]
    v_mfma_f32_16x16x32_bf16 v[40:43], a[152:155], a[36:39], v[40:43]
    v_mfma_f32_16x16x32_bf16 v[44:47], a[156:159], a[36:39], v[44:47]
    s_waitcnt vmcnt(3)
    v_accvgpr_read_b32 v21, a40
    v_accvgpr_read_b32 v22, a41
    v_max3_u32 v20, v20, v21, v22
    v_accvgpr_read_b32 v21, a42
    v_accvgpr_read_b32 v22, a43
    v_max3_u32 v20, v20, v21, v22
    v_mfma_f32_16x16x32_bf16 v[32:35], a[160:163], a[40:43], v[32:35]
    v_mfma_f32_16x16x32_bf16 v[36:39], a[164:167], a[40:43], v[36:39]
    v_mfma_f32_16x16x32_bf16 v[40:43], a[168:171], a[40:43], v[40:43]
    v_mfma_f32_16x16x32_bf16 v[44:47], a[172:175], a[40:43], v[44:47]
    s_waitcnt vmcnt(2)
    v_accvgpr_read_b32 v21, a44
    v_accvgpr_read_b32 v22, a45
    v_max3_u32 v20, v20, v21, v22
    v_accvgpr_read_b32 v21, a46
    v_accvgpr_read_b32 v22, a47
    v_max3_u32 v20, v20, v21, v22
    v_mfma_f32_16x16x32_bf16 v[32:35], a[176:179], a[44:47], v[32:35]
    v_mfma_f32_16x16x32_bf16 v[36:39], a[180:183], a[44:47], v[36:39]
    v_mfma_f32_16x16x32_bf16 v[40:43], a[184:187], a[44:47], v[40:43]
    v_mfma_f32_16x16x32_bf16 v[44:47], a[188:191], a[44:47], v[44:47]
    s_waitcnt vmcnt(1)
    v_accvgpr_read_b32 v21, a48
    v_accvgpr_read_b32 v22, a49
    v_max3_u32 v20, v20, v21, v22
    v_accvgpr_read_b32 v21, a50
    v_accvgpr_read_b32 v22, a51
    v_max3_u32 v20, v20, v21, v22
    v_mfma_f32_16x16x32_bf16 v[32:35], a[192:195], a[48:51], v[32:35]
    v_mfma_f32_16x16x32_bf16 v[36:39], a[196:199], a[48:51], v[36:39]
    v_mfma_f32_16x16x32_bf16 v[40:43], a[200:203], a[48:51], v[40:43]
    v_mfma_f32_16x16x32_bf16 v[44:47], a[204:207], a[48:51], v[44:47]
    s_waitcnt vmcnt(0)
    v_accvgpr_read_b32 v21, a52
    v_accvgpr_read_b32 v22, a53
    v_max3_u32 v20, v20, v21, v22
    v_accvgpr_read_b32 v21, a54
    v_accvgpr_read_b32 v22, a55
    v_max3_u32 v20, v20, v21, v22
    v_mfma_f32_16x16x32_bf16 v[32:35], a[208:211], a[52:55], v[32:35]
    v_mfma_f32_16x16x32_bf16 v[36:39], a[212:215], a[52:55], v[36:39]
    v_mfma_f32_16x16x32_bf16 v[40:43], a[216:219], a[52:55], v[40:43]
    v_mfma_f32_16x16x32_bf16 v[44:47], a[220:223], a[52:55], v[44:47]
    v_cmp_eq_u32 vcc, -1, v20
    s_cbranch_vccz L_nb_88
    s_add_u32 s55, s55, 1
    s_cmp_lt_u32 s55, 200000
    s_cbranch_scc1 L_nn_87_t
    s_branch L_nb_88
L_nn_89:
    s_mov_b32 s55, 0
    v_subrev_u32 v27, 0, v26
L_nn_89_t:
    buffer_load_dwordx4 a[56:59], v27, s[36:39], s79 offen sc1
    buffer_load_dwordx4 a[60:63], v27, s[36:39], s79 offen offset:2048 sc1
    buffer_load_dwordx4 a[64:67], v27, s[36:39], s80 offen sc1
    buffer_load_dwordx4 a[68:71], v27, s[36:39], s80 offen offset:2048 sc1
    buffer_load_dwordx4 a[72:75], v27, s[36:39], s81 offen sc1
    buffer_load_dwordx4 a[76:79], v27, s[36:39], s81 offen offset:2048 sc1
    buffer_load_dwordx4 a[80:83], v27, s[36:39], s82 offen sc1
    buffer_load_dwordx4 a[84:87], v27, s[36:39], s82 offen offset:2048 sc1
    buffer_load_dwordx4 a[88:91], v27, s[36:39], s83 offen sc1
    buffer_load_dwordx4 a[92:95], v27, s[36:39], s83 offen offset:2048 sc1
    buffer_load_dwordx4 a[96:99], v27, s[36:39], s84 offen sc1
    buffer_load_dwordx4 a[100:103], v27, s[36:39], s84 offen offset:2048 sc1
    buffer_load_dwordx4 a[104:107], v27, s[36:39], s85 offen sc1
    buffer_load_dwordx4 a[108:111], v27, s[36:39], s85 offen offset:2048 sc1
    v_mov_b32 v20, 0
    s_waitcnt vmcnt(13)
    v_accvgpr_read_b32 v21, a56
    v_accvgpr_read_b32 v22, a57
    v_max3_u32 v20, v20, v21, v22
    v_accvgpr_read_b32 v21, a58
    v_accvgpr_read_b32 v22, a59
    v_max3_u32 v20, v20, v21, v22
    v_mfma_f32_16x16x32_bf16 v[48:51], a[224:227], a[56:59], 0
    v_mfma_f32_16x16x32_bf16 v[52:55], a[228:231], a[56:59], 0
    v_mfma_f32_16x16x32_bf16 v[56:59], a[232:235], a[56:59], 0
    v_mfma_f32_16x16x32_bf16 v[60:63], a[236:239], a[56:59], 0
    s_waitcnt vmcnt(12)
    v_accvgpr_read_b32 v21, a60
    v_accvgpr_read_b32 v22, a61
    v_max3_u32 v20, v20, v21, v22
    v_accvgpr_read_b32 v21, a62
    v_accvgpr_read_b32 v22, a63
    v_max3_u32 v20, v20, v21, v22
    v_mfma_f32_16x16x32_bf16 v[48:51], a[240:243], a[60:63], v[48:51]
    v_mfma_f32_16x16x32_bf16 v[52:55], a[244:247], a[60:63], v[52:55]
    v_mfma_f32_16x16x32_bf16 v[56:59], a[248:251], a[60:63], v[56:59]
    v_mfma_f32_16x16x32_bf16 v[60:63], a[252:255], a[60:63], v[60:63]
    s_waitcnt vmcnt(11)
    v_accvgpr_read_b32 v21, a64
    v_accvgpr_read_b32 v22, a65
    v_max3_u32 v20, v20, v21, v22
    v_accvgpr_read_b32 v21, a66
    v_accvgpr_read_b32 v22, a67
    v_max3_u32 v20, v20, v21, v22
    v_mfma_f32_16x16x32_bf16 v[48:51], v[176:179], a[64:67], v[48:51]
    v_mfma_f32_16x16x32_bf16 v[52:55], v[180:183], a[64:67], v[52:55]
    v_mfma_f32_16x16x32_bf16 v[56:59], v[184:187], a[64:67], v[56:59]
    v_mfma_f32_16x16x32_bf16 v[60:63], v[188:191], a[64:67], v[60:63]
    s_waitcnt vmcnt(10)
    v_accvgpr_read_b32 v21, a68
    v_accvgpr_read_b32 v22, a69
    v_max3_u32 v20, v20, v21, v22
    v_accvgpr_read_b32 v21, a70
    v_accvgpr_read_b32 v22, a71
    v_max3_u32 v20, v20, v21, v22
    v_mfma_f32_16x16x32_bf16 v[48:51], v[192:195], a[68:71], v[48:51]
    v_mfma_f32_16x16x32_bf16 v[52:55], v[196:199], a[68:71], v[52:55]
    v_mfma_f32_16x16x32_bf16 v[56:59], v[200:203], a[68:71], v[56:59]
    v_mfma_f32_16x16x32_bf16 v[60:63], v[204:207], a[68:71], v[60:63]
    s_waitcnt vmcnt(9)
    v_accvgpr_read_b32 v21, a72
    v_accvgpr_read_b32 v22, a73
    v_max3_u32 v20, v20, v21, v22
    v_accvgpr_read_b32 v21, a74
    v_accvgpr_read_b32 v22, a75
    v_max3_u32 v20, v20, v21, v22
    v_mfma_f32_16x16x32_bf16 v[48:51], v[208:211], a[72:75], v[48:51]
    v_mfma_f32_16x16x32_bf16 v[52:55], v[212:215], a[72:75], v[52:55]
    v_mfma_f32_16x16x32_bf16 v[56:59], v[216:219], a[72:75], v[56:59]
    v_mfma_f32_16x16x32_bf16 v[60:63], v[220:223], a[72:75], v[60:63]
    s_waitcnt vmcnt(8)
    v_accvgpr_read_b32 v21, a76
    v_accvgpr_read_b32 v22, a77
    v_max3_u32 v20, v20, v21, v22
    v_accvgpr_read_b32 v21, a78
    v_accvgpr_read_b32 v22, a79
    v_max3_u32 v20, v20, v21, v22
    v_mfma_f32_16x16x32_bf16 v[48:51], v[224:227], a[76:79], v[48:51]
    v_mfma_f32_16x16x32_bf16 v[52:55], v[228:231], a[76:79], v[52:55]
    v_mfma_f32_16x16x32_bf16 v[56:59], v[232:235], a[76:79], v[56:59]
    v_mfma_f32_16x16x32_bf16 v[60:63], v[236:239], a[76:79], v[60:63]
    s_waitcnt vmcnt(7)
    v_accvgpr_read_b32 v21, a80
    v_accvgpr_read_b32 v22, a81
    v_max3_u32 v20, v20, v21, v22
    v_accvgpr_read_b32 v21, a82
    v_accvgpr_read_b32 v22, a83
    v_max3_u32 v20, v20, v21, v22
    v_mfma_f32_16x16x32_bf16 v[48:51], v[240:243], a[80:83], v[48:51]
    v_mfma_f32_16x16x32_bf16 v[52:55], v[244:247], a[80:83], v[52:55]
    v_mfma_f32_16x16x32_bf16 v[56:59], v[248:251], a[80:83], v[56:59]
    v_mfma_f32_16x16x32_bf16 v[60:63], v[252:255], a[80:83], v[60:63]
    s_waitcnt vmcnt(6)
    v_accvgpr_read_b32 v21, a84
    v_accvgpr_read_b32 v22, a85
    v_max3_u32 v20, v20, v21, v22
    v_accvgpr_read_b32 v21, a86
    v_accvgpr_read_b32 v22, a87
    v_max3_u32 v20, v20, v21, v22
    v_mfma_f32_16x16x32_bf16 v[48:51], a[112:115], a[84:87], v[48:51]
    v_mfma_f32_16x16x32_bf16 v[52:55], a[116:119], a[84:87], v[52:55]
    v_mfma_f32_16x16x32_bf16 v[56:59], a[120:123], a[84:87], v[56:59]
    v_mfma_f32_16x16x32_bf16 v[60:63], a[124:127], a[84:87], v[60:63]
    s_waitcnt vmcnt(5)
    v_accvgpr_read_b32 v21, a88
    v_accvgpr_read_b32 v22, a89
    v_max3_u32 v20, v20, v21, v22
    v_accvgpr_read_b32 v21, a90
    v_accvgpr_read_b32 v22, a91
    v_max3_u32 v20, v20, v21, v22
    v_mfma_f32_16x16x32_bf16 v[48:51], a[128:131], a[88:91], v[48:51]
    v_mfma_f32_16x16x32_bf16 v[52:55], a[132:135], a[88:91], v[52:55]
    v_mfma_f32_16x16x32_bf16 v[56:59], a[136:139], a[88:91], v[56:59]
    v_mfma_f32_16x16x32_bf16 v[60:63], a[140:143], a[88:91], v[60:63]
    s_waitcnt vmcnt(4)
    v_accvgpr_read_b32 v21, a92
    v_accvgpr_read_b32 v22, a93
    v_max3_u32 v20, v20, v21, v22
    v_accvgpr_read_b32 v21, a94
    v_accvgpr_read_b32 v22, a95
    v_max3_u32 v20, v20, v21, v22
    v_mfma_f32_16x16x32_bf16 v[48:51], a[144:147], a[92:95], v[48:51]
    v_mfma_f32_16x16x32_bf16 v[52:55], a[148:151], a[92:95], v[52:55]
    v_mfma_f32_16x16x32_bf16 v[56:59], a[152:155], a[92:95], v[56:59]
    v_mfma_f32_16x16x32_bf16 v[60:63], a[156:159], a[92:95], v[60:63]
    s_waitcnt vmcnt(3)
    v_accvgpr_read_b32 v21, a96
    v_accvgpr_read_b32 v22, a97
    v_max3_u32 v20, v20, v21, v22
    v_accvgpr_read_b32 v21, a98
    v_accvgpr_read_b32 v22, a99
    v_max3_u32 v20, v20, v21, v22
    v_mfma_f32_16x16x32_bf16 v[48:51], a[160:163], a[96:99], v[48:51]
    v_mfma_f32_16x16x32_bf16 v[52:55], a[164:167], a[96:99], v[52:55]
    v_mfma_f32_16x16x32_bf16 v[56:59], a[168:171], a[96:99], v[56:59]
    v_mfma_f32_16x16x32_bf16 v[60:63], a[172:175], a[96:99], v[60:63]
    s_waitcnt vmcnt(2)
    v_accvgpr_read_b32 v21, a100
    v_accvgpr_read_b32 v22, a101
    v_max3_u32 v20, v20, v21, v22
    v_accvgpr_read_b32 v21, a102
    v_accvgpr_read_b32 v22, a103
    v_max3_u32 v20, v20, v21, v22
    v_mfma_f32_16x16x32_bf16 v[48:51], a[176:179], a[100:103], v[48:51]
    v_mfma_f32_16x16x32_bf16 v[52:55], a[180:183], a[100:103], v[52:55]
    v_mfma_f32_16x16x32_bf16 v[56:59], a[184:187], a[100:103], v[56:59]
    v_mfma_f32_16x16x32_bf16 v[60:63], a[188:191], a[100:103], v[60:63]
    s_waitcnt vmcnt(1)
    v_accvgpr_read_b32 v21, a104
    v_accvgpr_read_b32 v22, a105
    v_max3_u32 v20, v20, v21, v22
    v_accvgpr_read_b32 v21, a106
    v_accvgpr_read_b32 v22, a107
    v_max3_u32 v20, v20, v21, v22
    v_mfma_f32_16x16x32_bf16 v[48:51], a[192:195], a[104:107], v[48:51]
    v_mfma_f32_16x16x32_bf16 v[52:55], a[196:199], a[104:107], v[52:55]
    v_mfma_f32_16x16x32_bf16 v[56:59], a[200:203], a[104:107], v[56:59]
    v_mfma_f32_16x16x32_bf16 v[60:63], a[204:207], a[104:107], v[60:63]
    s_waitcnt vmcnt(0)
    v_accvgpr_read_b32 v21, a108
    v_accvgpr_read_b32 v22, a109
    v_max3_u32 v20, v20, v21, v22
    v_accvgpr_read_b32 v21, a110
    v_accvgpr_read_b32 v22, a111
    v_max3_u32 v20, v20, v21, v22
    v_mfma_f32_16x16x32_bf16 v[48:51], a[208:211], a[108:111], v[48:51]
    v_mfma_f32_16x16x32_bf16 v[52:55], a[212:215], a[108:111], v[52:55]
    v_mfma_f32_16x16x32_bf16 v[56:59], a[216:219], a[108:111], v[56:59]
    v_mfma_f32_16x16x32_bf16 v[60:63], a[220:223], a[108:111], v[60:63]
    v_cmp_eq_u32 vcc, -1, v20
    s_cbranch_vccz L_nb_90
    s_add_u32 s55, s55, 1
    s_cmp_lt_u32 s55, 200000
    s_cbranch_scc1 L_nn_89_t
    s_branch L_nb_90
L_exit:
    s_endpgm
L_code_end:
.if (L_code_end - sequential_preLN__linear_attn_block__glu_gated_geglu__prompt_kernel) < 33024
.fill (33024 - (L_code_end - sequential_preLN__linear_attn_block__glu_gated_geglu__prompt_kernel)) / 4, 4, 0xbf810000
.endif
.section .rodata,"a"
.p2align 6
.amdhsa_kernel sequential_preLN__linear_attn_block__glu_gated_geglu__prompt_kernel
  .amdhsa_next_free_vgpr 512
  .amdhsa_next_free_sgpr 102
  .amdhsa_accum_offset 256
  .amdhsa_group_segment_fixed_size 0
  .amdhsa_kernarg_size 80
  .amdhsa_user_sgpr_count 2
  .amdhsa_user_sgpr_kernarg_segment_ptr 1
  .amdhsa_system_sgpr_workgroup_id_x 1
  .amdhsa_float_denorm_mode_32 3
.end_amdhsa_kernel
```
